```python
import torch

def _softmax(x, axis=-1):
    return torch.softmax(x, dim=axis)
def _gelu(x):
    return torch.nn.functional.gelu(x, approximate="tanh")
def _silu(x):
    return torch.nn.functional.silu(x)
def _sigmoid(x):
    return torch.sigmoid(x)
def _layernorm(x, axis=-1, eps=1e-5):
    m = x.mean(dim=axis, keepdim=True)
    v = x.var(dim=axis, keepdim=True, unbiased=False)
    return (x - m) / torch.sqrt(v + eps)
def _scatter_add(tgt, idx, src, axis=0):
    return tgt.clone().index_add_(axis, idx, src)
def _segment_sum(src, seg, n):
    out = torch.zeros((n,) + src.shape[1:], dtype=src.dtype)
    return out.index_add_(0, seg, src)
def _pad(x, pw):
    flat = tuple(v for pair in reversed(pw) for v in pair)
    return torch.nn.functional.pad(x, flat)

kernel_name = 'gated_mix__ssm_conv_s4__ssm_conv_s5__prompt'

def setup_inputs():

    _w = (lambda a: (lambda t: t.to(torch.bfloat16) if t.is_floating_point() else t)(torch.as_tensor(a)))
    def _A_setup():
        B, L, D, N = 1, 2048, 448, 256
        A_re = -(lambda _x: torch.exp(torch.as_tensor(_x)))((lambda *s: torch.randn(*s, dtype=torch.bfloat16) * 3.2)(D, N))
        A_im = torch.pi * (lambda *s: torch.randn(*s, dtype=torch.bfloat16) * 0.05)(D, N)
        B_re = (lambda *s: torch.randn(*s, dtype=torch.bfloat16) * 0.05)(D, N)
        B_im = (lambda *s: torch.randn(*s, dtype=torch.bfloat16) * 0.1)(D, N)
        C_re = (lambda *s: torch.randn(*s, dtype=torch.bfloat16) * 0.1)(D, N)
        C_im = (lambda *s: torch.randn(*s, dtype=torch.bfloat16) * 0.1)(D, N)
        log_dt = (lambda *s: torch.randn(*s, dtype=torch.bfloat16) * 0.05)(D) * 0.5 - 4.0
        Dskip = (lambda *s: torch.randn(*s, dtype=torch.bfloat16) * 0.05)(D)
        return {
            "u": _w((lambda *s: torch.randn(*s, dtype=torch.bfloat16) * 0.05)(B, L, D)),
            "A_re": _w(A_re),
            "A_im": _w(A_im),
            "B_re": _w(B_re),
            "B_im": _w(B_im),
            "C_re": _w(C_re),
            "C_im": _w(C_im),
            "log_dt": _w(log_dt),
            "Dskip": _w(Dskip),
        }
    _A_in = _A_setup()

    def _B_setup():
        B, S, D = 1, 2048, 448
        P = D
        Lambda_re = -0.5 * (lambda _x: torch.exp(torch.as_tensor(_x)))((lambda *s: torch.randn(*s, dtype=torch.bfloat16) * 0.2)(P))
        Lambda_im = (lambda *s: torch.randn(*s, dtype=torch.bfloat16) * 0.4)(P) * 1.0
        B_re = (lambda *s: torch.randn(*s, dtype=torch.bfloat16) * 0.2)(P, D) * (D ** -0.5)
        B_im = (lambda *s: torch.randn(*s, dtype=torch.bfloat16) * 0.2)(P, D) * (D ** -0.5)
        C_re = (lambda *s: torch.randn(*s, dtype=torch.bfloat16) * 0.2)(D, P) * (P ** -0.5)
        C_im = (lambda *s: torch.randn(*s, dtype=torch.bfloat16) * 0.2)(D, P) * (P ** -0.5)
        log_dt = (lambda *s: torch.randn(*s, dtype=torch.bfloat16) * 0.2)(P) * 0.3 - 2.0
        Dskip = (lambda *s: torch.randn(*s, dtype=torch.bfloat16) * 0.05)(D)
        return {
            "x": _w((lambda *s: torch.randn(*s, dtype=torch.bfloat16) * 0.05)(B, S, D)),
            "Lambda_re": _w(Lambda_re),
            "Lambda_im": _w(Lambda_im),
            "B_re": _w(B_re),
            "B_im": _w(B_im),
            "C_re": _w(C_re),
            "C_im": _w(C_im),
            "log_dt": _w(log_dt),
            "Dskip": _w(Dskip),
        }
    _B_in = _B_setup()

    return {
        "A_u": _A_in["u"],
        "A_A_re": _A_in["A_re"],
        "A_A_im": _A_in["A_im"],
        "A_B_re": _A_in["B_re"],
        "A_B_im": _A_in["B_im"],
        "A_C_re": _A_in["C_re"],
        "A_C_im": _A_in["C_im"],
        "A_log_dt": _A_in["log_dt"],
        "A_Dskip": _A_in["Dskip"],
        "B_x": _B_in["x"],
        "B_Lambda_re": _B_in["Lambda_re"],
        "B_Lambda_im": _B_in["Lambda_im"],
        "B_B_re": _B_in["B_re"],
        "B_B_im": _B_in["B_im"],
        "B_C_re": _B_in["C_re"],
        "B_C_im": _B_in["C_im"],
        "B_log_dt": _B_in["log_dt"],
        "B_Dskip": _B_in["Dskip"],
        "gate_w": _w((lambda *s: torch.randn(*s, dtype=torch.bfloat16) * 0.05)(448) * 16.0),
    }

def reference(A_u, A_A_re, A_A_im, A_B_re, A_B_im, A_C_re, A_C_im, A_log_dt, A_Dskip, B_x, B_Lambda_re, B_Lambda_im, B_B_re, B_B_im, B_C_re, B_C_im, B_log_dt, B_Dskip, gate_w):
    def _A_ref(u, A_re, A_im, B_re, B_im, C_re, C_im, log_dt, Dskip):
        Bsz, L, D = u.shape
        dt = torch.exp(log_dt)[:, None]
        A = A_re + 1j * A_im
        Bc = B_re + 1j * B_im
        Cc = C_re + 1j * C_im
        logdA = dt * A
        dB = dt * Bc
        l = (lambda x, dt: x.to(dt))(torch.arange(L), A_re.dtype)
        P = torch.exp(logdA[:, :, None] * l[None, None, :])
        K = torch.einsum("dn,dnl,dn->dl", Cc, P, dB).real
        L2 = 2 * L
        Kp = _pad(K, ((0, 0), (0, L)))
        up = (lambda x, *d: x.permute(*d))(u, 0, 2, 1)
        up = _pad(up, ((0, 0), (0, 0), (0, L)))
        Kf = (lambda x, axes=(-2,-1): torch.fft.rfft2(x.float(), dim=axes))(Kp[:, None, :], axes=(-2, -1))
        Uf = (lambda x, axes=(-2,-1): torch.fft.rfft2(x.float(), dim=axes))(up[:, :, None, :], axes=(-2, -1))
        Yf = Uf * Kf[None, :, :, :]
        y = (lambda x, s, axes=(-2,-1): torch.fft.irfft2(x, s=s, dim=axes).to(torch.bfloat16))(Yf, (1, L2), axes=(-2, -1))[:, :, 0, :L]
        y = (lambda x, *d: x.permute(*d))(y, 0, 2, 1) + u * Dskip[None, None, :]
        return y

    def _B_ref(x, Lambda_re, Lambda_im, B_re, B_im, C_re, C_im, log_dt, Dskip):
        Bsz, L, H = x.shape
        Lam = Lambda_re + 1j * Lambda_im
        Bmat = B_re + 1j * B_im
        Cmat = C_re + 1j * C_im
        dt = torch.exp(log_dt)
        Lam_bar = torch.exp(dt * Lam)
        B_bar = ((Lam_bar - 1.0) / Lam)[:, None] * Bmat
        Bu = torch.einsum("bld,pd->blp", x + 0j, B_bar)
        h = torch.zeros_like(Bu[:, 0, :])
        hs = []
        for t in range(L):
            h = Lam_bar[None, :] * h + Bu[:, t, :]
            hs.append(h)
        hseq = torch.stack(hs, 1)
        y = 2.0 * torch.einsum("blp,dp->bld", hseq, Cmat).real + x * Dskip[None, None, :]
        return y

    x = A_u
    g = _sigmoid((x * gate_w).sum(-1, keepdims=True))
    a = _A_ref(x, A_A_re, A_A_im, A_B_re, A_B_im, A_C_re, A_C_im, A_log_dt, A_Dskip)
    b = _B_ref(x, B_Lambda_re, B_Lambda_im, B_B_re, B_B_im, B_C_re, B_C_im, B_log_dt, B_Dskip)
    return g * a + (1 - g) * b
```

```asm
; @launch grid=(448,1,1) block=(256,1,1) lds=81920
.amdgcn_target "amdgcn-amd-amdhsa--gfx950"
.text
.globl gated_mix__ssm_conv_s4__ssm_conv_s5__prompt_kernel
.p2align 8
.type gated_mix__ssm_conv_s4__ssm_conv_s5__prompt_kernel,@function
gated_mix__ssm_conv_s4__ssm_conv_s5__prompt_kernel:
    s_cmp_ge_u32 s2, 448
    s_cbranch_scc1 L_END
    s_cmp_ge_u32 s2, 32
    s_cbranch_scc1 L_NOWARM
    s_getpc_b64 s[4:5]
    v_lshlrev_b32 v4, 7, v0
    v_min_u32 v4, L_END-L_NOWARM, v4
    v_mov_b32 v5, s5
    v_add_co_u32 v4, vcc, s4, v4
    s_nop 1
    v_addc_co_u32 v5, vcc, 0, v5, vcc
    global_load_dword v255, v[4:5], off
L_NOWARM:
    v_and_b32 v1, 63, v0
    v_lshrrev_b32 v4, 6, v0
    v_and_b32 v2, 15, v0
    v_bfe_u32 v3, v0, 4, 2
    v_readfirstlane_b32 s3, v4
    s_cmp_lt_u32 s2, 224
    s_cbranch_scc1 L_AROLE
    s_load_dwordx2 s[36:37], s[0:1], 160
    s_mov_b32 s38, 256
    s_mov_b32 s39, 0x20000
    s_load_dwordx2 s[8:9], s[0:1], 0
    s_mov_b32 s10, 1835008
    s_mov_b32 s11, 0x20000
    s_load_dwordx2 s[12:13], s[0:1], 96
    s_mov_b32 s14, 401408
    s_mov_b32 s15, 0x20000
    s_load_dwordx2 s[16:17], s[0:1], 104
    s_mov_b32 s18, 401408
    s_mov_b32 s19, 0x20000
    s_load_dwordx2 s[40:41], s[0:1], 144
    s_mov_b32 s42, 896
    s_mov_b32 s43, 0x20000
    s_load_dwordx2 s[44:45], s[0:1], 80
    s_mov_b32 s46, 896
    s_mov_b32 s47, 0x20000
    s_load_dwordx2 s[48:49], s[0:1], 88
    s_mov_b32 s50, 896
    s_mov_b32 s51, 0x20000
    s_load_dwordx2 s[52:53], s[0:1], 128
    s_mov_b32 s54, 896
    s_mov_b32 s55, 0x20000
    s_load_dwordx2 s[28:29], s[0:1], 168
    s_mov_b32 s30, 33554432
    s_mov_b32 s31, 0x20000
    s_load_dwordx2 s[32:33], s[0:1], 152
    s_mov_b32 s34, 3670016
    s_mov_b32 s35, 0x20000
    s_load_dwordx2 s[56:57], s[0:1], 136
    s_mov_b32 s58, 896
    s_mov_b32 s59, 0x20000
    s_sub_u32 s63, s2, 224
    s_and_b32 s4, s2, 7
    s_lshl_b32 s4, s4, 2
    s_bfe_u32 s71, s63, 0x20003
    s_add_u32 s4, s4, s71
    s_lshr_b32 s5, s63, 5
    v_bfe_u32 v5, v1, 5, 1
    v_lshlrev_b32 v5, 4, v5
    v_bfe_u32 v6, v1, 3, 2
    v_add_u32 v5, v5, v6
    s_lshl_b32 s6, s4, 6
    s_lshl_b32 s7, s3, 2
    s_add_u32 s6, s6, s7
    v_add_u32 v5, s6, v5
    v_mul_u32_u24 v5, 896, v5
    v_and_b32 v6, 7, v1
    v_xor_b32 v6, v6, v3
    v_lshl_add_u32 v5, v6, 4, v5
    s_lshl_b32 s6, s5, 6
    s_lshl_b32 s7, s3, 4
    s_add_u32 s64, s6, s7
    v_add_u32 v7, s64, v2
    v_lshlrev_b32 v7, 1, v7
    v_lshlrev_b32 v9, 4, v1
    s_lshl_b32 s65, s5, 7
    v_add_u32 v8, s65, v9
    v_subrev_u32 v10, 896, v8
    v_min_u32 v8, v8, v10
    v_and_b32 v6, 12, v2
    v_add_u32 v6, s64, v6
    v_mul_u32_u24 v6, 896, v6
    v_and_b32 v10, 3, v2
    v_lshl_add_u32 v6, v10, 4, v6
    v_lshl_add_u32 v10, v3, 6, s65
    v_add_u32 v11, 0, v10
    v_subrev_u32 v12, 896, v11
    v_min_u32 v11, v11, v12
    v_add_u32 v200, v6, v11
    v_add_u32 v11, 256, v10
    v_subrev_u32 v12, 896, v11
    v_min_u32 v11, v11, v12
    v_add_u32 v201, v6, v11
    v_add_u32 v11, 512, v10
    v_subrev_u32 v12, 896, v11
    v_min_u32 v11, v11, v12
    v_add_u32 v202, v6, v11
    v_and_b32 v6, 14, v2
    v_add_u32 v6, s64, v6
    v_mul_u32_u24 v6, 896, v6
    v_and_b32 v10, 1, v2
    v_lshl_add_u32 v6, v10, 4, v6
    v_and_b32 v10, 1, v3
    v_lshlrev_b32 v10, 6, v10
    v_and_b32 v11, 2, v3
    v_lshl_add_u32 v204, v11, 4, v10
    s_add_u32 s6, s65, 768
    s_sub_u32 s7, s6, 896
    s_min_u32 s6, s6, s7
    v_add3_u32 v203, v6, v204, s6
    s_waitcnt lgkmcnt(0)
    buffer_load_ushort v228, v7, s[44:47], 0 offen
    buffer_load_ushort v229, v7, s[48:51], 0 offen
    buffer_load_ushort v230, v7, s[52:55], 0 offen
    buffer_load_ushort v14, v7, s[56:59], 0 offen
    s_mov_b32 m0, 57344
    s_nop 0
    buffer_load_dwordx4 v8, s[40:43], 0 offen lds
    s_lshl_b32 s66, s3, 11
    s_add_u32 m0, s66, 0
    s_add_u32 s6, s65, 28672
    buffer_load_dwordx4 v5, s[8:11], s65 offen lds
    s_add_u32 m0, s66, 1024
    s_add_u32 s65, s65, 128
    buffer_load_dwordx4 v5, s[8:11], s6 offen lds
    s_cmp_eq_u32 s65, 896
    s_cselect_b32 s65, 0, s65
    s_add_u32 m0, s66, 8192
    s_add_u32 s6, s65, 28672
    buffer_load_dwordx4 v5, s[8:11], s65 offen lds
    s_add_u32 m0, s66, 9216
    s_add_u32 s65, s65, 128
    buffer_load_dwordx4 v5, s[8:11], s6 offen lds
    s_cmp_eq_u32 s65, 896
    s_cselect_b32 s65, 0, s65
    buffer_load_dwordx4 v[16:19], v200, s[12:15], 0 offen offset:0
    buffer_load_dwordx4 v[20:23], v200, s[12:15], 0 offen offset:896
    buffer_load_dwordx4 v[24:27], v200, s[12:15], 0 offen offset:1792
    buffer_load_dwordx4 v[28:31], v200, s[12:15], 0 offen offset:2688
    buffer_load_dwordx4 v[32:35], v200, s[16:19], 0 offen offset:0
    buffer_load_dwordx4 v[36:39], v200, s[16:19], 0 offen offset:896
    buffer_load_dwordx4 v[40:43], v200, s[16:19], 0 offen offset:1792
    buffer_load_dwordx4 v[44:47], v200, s[16:19], 0 offen offset:2688
    v_lshrrev_b32 v10, 2, v2
    v_lshl_add_u32 v10, v3, 2, v10
    v_bfe_u32 v12, v2, 1, 1
    s_lshl_b32 s6, s3, 1
    v_add_u32 v12, s6, v12
    v_bfe_u32 v13, v10, 1, 2
    v_xor_b32 v12, v12, v13
    v_lshlrev_b32 v10, 7, v10
    v_lshl_add_u32 v10, v12, 4, v10
    v_and_b32 v12, 1, v2
    v_lshl_add_u32 v10, v12, 3, v10
    v_lshrrev_b32 v11, 3, v1
    v_add_u32 v11, s64, v11
    v_lshlrev_b32 v11, 12, v11
    v_and_b32 v12, 7, v1
    v_lshl_add_u32 v11, v12, 4, v11
    s_lshl_b32 s6, s4, 7
    v_add_u32 v11, s6, v11
    v_bfe_u32 v211, v2, 1, 2
    v_lshlrev_b32 v211, 4, v211
    v_lshl_add_u32 v211, v2, 7, v211
    v_xor_b32 v209, v211, v204
    v_xor_b32 v210, 16, v209
    v_and_b32 v212, 1, v3
    v_lshl_add_u32 v211, v212, 6, v211
    v_lshrrev_b32 v212, 1, v3
    v_lshl_add_u32 v205, v212, 13, v211
    v_xor_b32 v206, 16, v205
    v_xor_b32 v207, 32, v205
    v_xor_b32 v208, 48, v205
    v_bfe_u32 v6, v1, 3, 2
    v_mul_u32_u24 v6, 28, v6
    v_and_b32 v12, 7, v1
    v_min_u32 v12, 6, v12
    v_add_u32 v6, v6, v12
    s_mul_i32 s6, s3, 7
    s_mul_i32 s7, s5, 112
    s_add_u32 s6, s6, s7
    v_add_u32 v6, s6, v6
    v_lshlrev_b32 v6, 7, v6
    v_add_u32 v6, 3260416, v6
    s_mul_i32 s6, s3, 7168
    v_add_u32 v4, s6, v9
    s_add_u32 s6, s3, 0
    s_and_b32 s6, s6, 3
    s_lshl_b32 s7, s5, 2
    s_add_u32 s6, s6, s7
    s_mul_i32 s6, s6, 28672
    s_add_u32 s44, s6, 2097152
    s_add_u32 s6, s3, 1
    s_and_b32 s6, s6, 3
    s_lshl_b32 s7, s5, 2
    s_add_u32 s6, s6, s7
    s_mul_i32 s6, s6, 28672
    s_add_u32 s45, s6, 2097152
    s_add_u32 s6, s3, 2
    s_and_b32 s6, s6, 3
    s_lshl_b32 s7, s5, 2
    s_add_u32 s6, s6, s7
    s_mul_i32 s6, s6, 28672
    s_add_u32 s46, s6, 2097152
    s_add_u32 s6, s3, 3
    s_and_b32 s6, s6, 3
    s_lshl_b32 s7, s5, 2
    s_add_u32 s6, s6, s7
    s_mul_i32 s6, s6, 28672
    s_add_u32 s47, s6, 2097152
    s_mov_b32 s48, 0
    s_mov_b32 s49, 1024
    s_mov_b32 s50, 2048
    s_mov_b32 s51, 3072
    s_mov_b32 s52, 4096
    s_mov_b32 s53, 5120
    s_mov_b32 s54, 6144
    s_lshl_b32 s67, s64, 1
    s_add_u32 s67, s67, s4
    s_lshl_b32 s6, s67, 7
    s_add_u32 s55, s6, 2899968
    s_add_u32 m0, s66, 16384
    s_add_u32 s6, s65, 28672
    buffer_load_dwordx4 v5, s[8:11], s65 offen lds
    s_add_u32 m0, s66, 17408
    s_add_u32 s65, s65, 128
    buffer_load_dwordx4 v5, s[8:11], s6 offen lds
    s_cmp_eq_u32 s65, 896
    s_cselect_b32 s65, 0, s65
    s_add_u32 m0, s66, 24576
    s_add_u32 s6, s65, 28672
    buffer_load_dwordx4 v5, s[8:11], s65 offen lds
    s_add_u32 m0, s66, 25600
    s_add_u32 s65, s65, 128
    buffer_load_dwordx4 v5, s[8:11], s6 offen lds
    s_cmp_eq_u32 s65, 896
    s_cselect_b32 s65, 0, s65
    buffer_load_dwordx4 v[48:51], v201, s[12:15], 0 offen offset:0
    buffer_load_dwordx4 v[52:55], v201, s[12:15], 0 offen offset:896
    buffer_load_dwordx4 v[56:59], v201, s[12:15], 0 offen offset:1792
    buffer_load_dwordx4 v[60:63], v201, s[12:15], 0 offen offset:2688
    buffer_load_dwordx4 v[64:67], v201, s[16:19], 0 offen offset:0
    buffer_load_dwordx4 v[68:71], v201, s[16:19], 0 offen offset:896
    buffer_load_dwordx4 v[72:75], v201, s[16:19], 0 offen offset:1792
    buffer_load_dwordx4 v[76:79], v201, s[16:19], 0 offen offset:2688
    s_setprio 2
    buffer_load_dword v15, off, s[36:39], 0 sc1
    s_waitcnt vmcnt(13)
    s_barrier
    ds_read_b64_tr_b16 v[192:193], v10 offset:0
    ds_read_b64_tr_b16 v[194:195], v10 offset:2048
    ds_read_b64_tr_b16 v[196:197], v10 offset:4096
    ds_read_b64_tr_b16 v[198:199], v10 offset:6144
    s_mul_i32 s6, s3, 2304
    v_mul_u32_u24 v211, 144, v2
    v_lshl_add_u32 v211, v3, 5, v211
    v_add_u32 v211, s6, v211
    v_lshrrev_b32 v10, 3, v1
    v_lshl_add_u32 v10, v10, 4, v9
    v_add_u32 v10, s6, v10
    s_mov_b32 vcc_lo, 0x55555555
    s_mov_b32 vcc_hi, 0x55555555
    v_cndmask_b32_dpp v212, v20, v16, vcc quad_perm:[1,0,3,2] row_mask:0xf bank_mask:0xf
    v_cndmask_b32_dpp v213, v21, v17, vcc quad_perm:[1,0,3,2] row_mask:0xf bank_mask:0xf
    v_cndmask_b32_dpp v214, v22, v18, vcc quad_perm:[1,0,3,2] row_mask:0xf bank_mask:0xf
    v_cndmask_b32_dpp v215, v23, v19, vcc quad_perm:[1,0,3,2] row_mask:0xf bank_mask:0xf
    s_waitcnt lgkmcnt(0)
    ds_write_b128 v211, v[192:195] offset:59392
    ds_write_b128 v211, v[196:199] offset:59408
    ds_read_b128 v[192:195], v10 offset:59392
    ds_read_b128 v[196:199], v10 offset:60544
    v_cndmask_b32_dpp v220, v28, v24, vcc quad_perm:[1,0,3,2] row_mask:0xf bank_mask:0xf
    v_cndmask_b32_dpp v221, v29, v25, vcc quad_perm:[1,0,3,2] row_mask:0xf bank_mask:0xf
    v_cndmask_b32_dpp v222, v30, v26, vcc quad_perm:[1,0,3,2] row_mask:0xf bank_mask:0xf
    v_cndmask_b32_dpp v223, v31, v27, vcc quad_perm:[1,0,3,2] row_mask:0xf bank_mask:0xf
    s_not_b64 vcc, vcc
    v_cndmask_b32_dpp v216, v16, v20, vcc quad_perm:[1,0,3,2] row_mask:0xf bank_mask:0xf
    v_cndmask_b32_dpp v217, v17, v21, vcc quad_perm:[1,0,3,2] row_mask:0xf bank_mask:0xf
    v_cndmask_b32_dpp v218, v18, v22, vcc quad_perm:[1,0,3,2] row_mask:0xf bank_mask:0xf
    v_cndmask_b32_dpp v219, v19, v23, vcc quad_perm:[1,0,3,2] row_mask:0xf bank_mask:0xf
    s_mov_b32 s6, 32768
    s_waitcnt lgkmcnt(0)
    buffer_store_dwordx4 v[192:195], v11, s[28:31], 0 offen sc1
    buffer_store_dwordx4 v[196:199], v11, s[28:31], s6 offen sc1
    ds_read_b128 v[160:163], v205 offset:0
    ds_read_b128 v[164:167], v205 offset:2048
    ds_read_b128 v[168:171], v205 offset:4096
    ds_read_b128 v[172:175], v205 offset:6144
    s_add_u32 m0, s66, 32768
    s_add_u32 s6, s65, 28672
    buffer_load_dwordx4 v5, s[8:11], s65 offen lds
    s_add_u32 m0, s66, 33792
    s_add_u32 s65, s65, 128
    v_cndmask_b32_dpp v224, v24, v28, vcc quad_perm:[1,0,3,2] row_mask:0xf bank_mask:0xf
    v_cndmask_b32_dpp v225, v25, v29, vcc quad_perm:[1,0,3,2] row_mask:0xf bank_mask:0xf
    v_cndmask_b32_dpp v226, v26, v30, vcc quad_perm:[1,0,3,2] row_mask:0xf bank_mask:0xf
    v_cndmask_b32_dpp v227, v27, v31, vcc quad_perm:[1,0,3,2] row_mask:0xf bank_mask:0xf
    s_mov_b32 vcc_lo, 0x33333333
    s_mov_b32 vcc_hi, 0x33333333
    buffer_load_dwordx4 v5, s[8:11], s6 offen lds
    s_cmp_eq_u32 s65, 896
    s_cselect_b32 s65, 0, s65
    s_add_u32 m0, s66, 40960
    s_add_u32 s6, s65, 28672
    v_cndmask_b32_dpp v16, v220, v212, vcc quad_perm:[2,3,0,1] row_mask:0xf bank_mask:0xf
    v_cndmask_b32_dpp v17, v221, v213, vcc quad_perm:[2,3,0,1] row_mask:0xf bank_mask:0xf
    v_cndmask_b32_dpp v18, v222, v214, vcc quad_perm:[2,3,0,1] row_mask:0xf bank_mask:0xf
    v_cndmask_b32_dpp v19, v223, v215, vcc quad_perm:[2,3,0,1] row_mask:0xf bank_mask:0xf
    buffer_load_dwordx4 v5, s[8:11], s65 offen lds
    s_add_u32 m0, s66, 41984
    s_add_u32 s65, s65, 128
    v_cndmask_b32_dpp v20, v224, v216, vcc quad_perm:[2,3,0,1] row_mask:0xf bank_mask:0xf
    v_cndmask_b32_dpp v21, v225, v217, vcc quad_perm:[2,3,0,1] row_mask:0xf bank_mask:0xf
    v_cndmask_b32_dpp v22, v226, v218, vcc quad_perm:[2,3,0,1] row_mask:0xf bank_mask:0xf
    v_cndmask_b32_dpp v23, v227, v219, vcc quad_perm:[2,3,0,1] row_mask:0xf bank_mask:0xf
    s_not_b64 vcc, vcc
    buffer_load_dwordx4 v5, s[8:11], s6 offen lds
    s_cmp_eq_u32 s65, 896
    s_cselect_b32 s65, 0, s65
    v_cndmask_b32_dpp v24, v212, v220, vcc quad_perm:[2,3,0,1] row_mask:0xf bank_mask:0xf
    v_cndmask_b32_dpp v25, v213, v221, vcc quad_perm:[2,3,0,1] row_mask:0xf bank_mask:0xf
    v_cndmask_b32_dpp v26, v214, v222, vcc quad_perm:[2,3,0,1] row_mask:0xf bank_mask:0xf
    v_cndmask_b32_dpp v27, v215, v223, vcc quad_perm:[2,3,0,1] row_mask:0xf bank_mask:0xf
    buffer_load_dwordx4 v[80:83], v202, s[12:15], 0 offen offset:0
    v_cndmask_b32_dpp v28, v216, v224, vcc quad_perm:[2,3,0,1] row_mask:0xf bank_mask:0xf
    v_cndmask_b32_dpp v29, v217, v225, vcc quad_perm:[2,3,0,1] row_mask:0xf bank_mask:0xf
    v_cndmask_b32_dpp v30, v218, v226, vcc quad_perm:[2,3,0,1] row_mask:0xf bank_mask:0xf
    v_cndmask_b32_dpp v31, v219, v227, vcc quad_perm:[2,3,0,1] row_mask:0xf bank_mask:0xf
    s_mov_b32 vcc_lo, 0x55555555
    s_mov_b32 vcc_hi, 0x55555555
    buffer_load_dwordx4 v[84:87], v202, s[12:15], 0 offen offset:896
    v_cndmask_b32_dpp v212, v36, v32, vcc quad_perm:[1,0,3,2] row_mask:0xf bank_mask:0xf
    v_cndmask_b32_dpp v213, v37, v33, vcc quad_perm:[1,0,3,2] row_mask:0xf bank_mask:0xf
    v_cndmask_b32_dpp v214, v38, v34, vcc quad_perm:[1,0,3,2] row_mask:0xf bank_mask:0xf
    v_cndmask_b32_dpp v215, v39, v35, vcc quad_perm:[1,0,3,2] row_mask:0xf bank_mask:0xf
    buffer_load_dwordx4 v[88:91], v202, s[12:15], 0 offen offset:1792
    v_cndmask_b32_dpp v220, v44, v40, vcc quad_perm:[1,0,3,2] row_mask:0xf bank_mask:0xf
    v_cndmask_b32_dpp v221, v45, v41, vcc quad_perm:[1,0,3,2] row_mask:0xf bank_mask:0xf
    v_cndmask_b32_dpp v222, v46, v42, vcc quad_perm:[1,0,3,2] row_mask:0xf bank_mask:0xf
    v_cndmask_b32_dpp v223, v47, v43, vcc quad_perm:[1,0,3,2] row_mask:0xf bank_mask:0xf
    s_not_b64 vcc, vcc
    buffer_load_dwordx4 v[92:95], v202, s[12:15], 0 offen offset:2688
    v_cndmask_b32_dpp v216, v32, v36, vcc quad_perm:[1,0,3,2] row_mask:0xf bank_mask:0xf
    v_cndmask_b32_dpp v217, v33, v37, vcc quad_perm:[1,0,3,2] row_mask:0xf bank_mask:0xf
    v_cndmask_b32_dpp v218, v34, v38, vcc quad_perm:[1,0,3,2] row_mask:0xf bank_mask:0xf
    v_cndmask_b32_dpp v219, v35, v39, vcc quad_perm:[1,0,3,2] row_mask:0xf bank_mask:0xf
    buffer_load_dwordx4 v[96:99], v202, s[16:19], 0 offen offset:0
    v_cndmask_b32_dpp v224, v40, v44, vcc quad_perm:[1,0,3,2] row_mask:0xf bank_mask:0xf
    v_cndmask_b32_dpp v225, v41, v45, vcc quad_perm:[1,0,3,2] row_mask:0xf bank_mask:0xf
    v_cndmask_b32_dpp v226, v42, v46, vcc quad_perm:[1,0,3,2] row_mask:0xf bank_mask:0xf
    v_cndmask_b32_dpp v227, v43, v47, vcc quad_perm:[1,0,3,2] row_mask:0xf bank_mask:0xf
    s_mov_b32 vcc_lo, 0x33333333
    s_mov_b32 vcc_hi, 0x33333333
    buffer_load_dwordx4 v[100:103], v202, s[16:19], 0 offen offset:896
    v_cndmask_b32_dpp v32, v220, v212, vcc quad_perm:[2,3,0,1] row_mask:0xf bank_mask:0xf
    v_cndmask_b32_dpp v33, v221, v213, vcc quad_perm:[2,3,0,1] row_mask:0xf bank_mask:0xf
    v_cndmask_b32_dpp v34, v222, v214, vcc quad_perm:[2,3,0,1] row_mask:0xf bank_mask:0xf
    v_cndmask_b32_dpp v35, v223, v215, vcc quad_perm:[2,3,0,1] row_mask:0xf bank_mask:0xf
    buffer_load_dwordx4 v[104:107], v202, s[16:19], 0 offen offset:1792
    v_cndmask_b32_dpp v36, v224, v216, vcc quad_perm:[2,3,0,1] row_mask:0xf bank_mask:0xf
    v_cndmask_b32_dpp v37, v225, v217, vcc quad_perm:[2,3,0,1] row_mask:0xf bank_mask:0xf
    v_cndmask_b32_dpp v38, v226, v218, vcc quad_perm:[2,3,0,1] row_mask:0xf bank_mask:0xf
    v_cndmask_b32_dpp v39, v227, v219, vcc quad_perm:[2,3,0,1] row_mask:0xf bank_mask:0xf
    s_not_b64 vcc, vcc
    buffer_load_dwordx4 v[108:111], v202, s[16:19], 0 offen offset:2688
    v_cndmask_b32_dpp v40, v212, v220, vcc quad_perm:[2,3,0,1] row_mask:0xf bank_mask:0xf
    v_cndmask_b32_dpp v41, v213, v221, vcc quad_perm:[2,3,0,1] row_mask:0xf bank_mask:0xf
    v_cndmask_b32_dpp v42, v214, v222, vcc quad_perm:[2,3,0,1] row_mask:0xf bank_mask:0xf
    v_cndmask_b32_dpp v43, v215, v223, vcc quad_perm:[2,3,0,1] row_mask:0xf bank_mask:0xf
    v_cndmask_b32_dpp v44, v216, v224, vcc quad_perm:[2,3,0,1] row_mask:0xf bank_mask:0xf
    v_cndmask_b32_dpp v45, v217, v225, vcc quad_perm:[2,3,0,1] row_mask:0xf bank_mask:0xf
    v_cndmask_b32_dpp v46, v218, v226, vcc quad_perm:[2,3,0,1] row_mask:0xf bank_mask:0xf
    v_cndmask_b32_dpp v47, v219, v227, vcc quad_perm:[2,3,0,1] row_mask:0xf bank_mask:0xf
    s_waitcnt vmcnt(15)
    s_barrier
    buffer_load_dword v232, v6, s[28:31], 0 offen sc1
    ds_read_b128 v[176:179], v206 offset:0
    ds_read_b128 v[180:183], v206 offset:2048
    ds_read_b128 v[184:187], v206 offset:4096
    ds_read_b128 v[188:191], v206 offset:6144
    s_waitcnt lgkmcnt(4)
    v_mfma_f32_16x16x32_bf16 v[128:131], v[160:163], v[16:19], 0
    s_mov_b32 vcc_lo, 0x55555555
    s_mov_b32 vcc_hi, 0x55555555
    v_cndmask_b32_dpp v212, v52, v48, vcc quad_perm:[1,0,3,2] row_mask:0xf bank_mask:0xf
    v_cndmask_b32_dpp v213, v53, v49, vcc quad_perm:[1,0,3,2] row_mask:0xf bank_mask:0xf
    v_mfma_f32_16x16x32_bf16 v[144:147], v[160:163], v[32:35], 0
    v_cndmask_b32_dpp v214, v54, v50, vcc quad_perm:[1,0,3,2] row_mask:0xf bank_mask:0xf
    v_cndmask_b32_dpp v215, v55, v51, vcc quad_perm:[1,0,3,2] row_mask:0xf bank_mask:0xf
    v_mfma_f32_16x16x32_bf16 v[132:135], v[164:167], v[16:19], 0
    v_cndmask_b32_dpp v220, v60, v56, vcc quad_perm:[1,0,3,2] row_mask:0xf bank_mask:0xf
    v_cndmask_b32_dpp v221, v61, v57, vcc quad_perm:[1,0,3,2] row_mask:0xf bank_mask:0xf
    v_mfma_f32_16x16x32_bf16 v[148:151], v[164:167], v[32:35], 0
    v_cndmask_b32_dpp v222, v62, v58, vcc quad_perm:[1,0,3,2] row_mask:0xf bank_mask:0xf
    v_cndmask_b32_dpp v223, v63, v59, vcc quad_perm:[1,0,3,2] row_mask:0xf bank_mask:0xf
    s_not_b64 vcc, vcc
    s_add_u32 m0, s66, 49152
    s_add_u32 s6, s65, 28672
    buffer_load_dwordx4 v5, s[8:11], s65 offen lds
    s_add_u32 m0, s66, 50176
    s_add_u32 s65, s65, 128
    v_mfma_f32_16x16x32_bf16 v[136:139], v[168:171], v[16:19], 0
    v_cndmask_b32_dpp v216, v48, v52, vcc quad_perm:[1,0,3,2] row_mask:0xf bank_mask:0xf
    v_cndmask_b32_dpp v217, v49, v53, vcc quad_perm:[1,0,3,2] row_mask:0xf bank_mask:0xf
    v_mfma_f32_16x16x32_bf16 v[152:155], v[168:171], v[32:35], 0
    v_cndmask_b32_dpp v218, v50, v54, vcc quad_perm:[1,0,3,2] row_mask:0xf bank_mask:0xf
    v_cndmask_b32_dpp v219, v51, v55, vcc quad_perm:[1,0,3,2] row_mask:0xf bank_mask:0xf
    v_mfma_f32_16x16x32_bf16 v[140:143], v[172:175], v[16:19], 0
    v_cndmask_b32_dpp v224, v56, v60, vcc quad_perm:[1,0,3,2] row_mask:0xf bank_mask:0xf
    v_cndmask_b32_dpp v225, v57, v61, vcc quad_perm:[1,0,3,2] row_mask:0xf bank_mask:0xf
    v_mfma_f32_16x16x32_bf16 v[156:159], v[172:175], v[32:35], 0
    v_cndmask_b32_dpp v226, v58, v62, vcc quad_perm:[1,0,3,2] row_mask:0xf bank_mask:0xf
    v_cndmask_b32_dpp v227, v59, v63, vcc quad_perm:[1,0,3,2] row_mask:0xf bank_mask:0xf
    s_mov_b32 vcc_lo, 0x33333333
    s_mov_b32 vcc_hi, 0x33333333
    buffer_load_dwordx4 v5, s[8:11], s6 offen lds
    s_cmp_eq_u32 s65, 896
    s_cselect_b32 s65, 0, s65
    ds_read_b128 v[160:163], v207 offset:0
    ds_read_b128 v[164:167], v207 offset:2048
    ds_read_b128 v[168:171], v207 offset:4096
    ds_read_b128 v[172:175], v207 offset:6144
    s_waitcnt lgkmcnt(4)
    v_mfma_f32_16x16x32_bf16 v[128:131], v[176:179], v[20:23], v[128:131]
    v_cndmask_b32_dpp v48, v220, v212, vcc quad_perm:[2,3,0,1] row_mask:0xf bank_mask:0xf
    v_cndmask_b32_dpp v49, v221, v213, vcc quad_perm:[2,3,0,1] row_mask:0xf bank_mask:0xf
    v_mfma_f32_16x16x32_bf16 v[144:147], v[176:179], v[36:39], v[144:147]
    v_cndmask_b32_dpp v50, v222, v214, vcc quad_perm:[2,3,0,1] row_mask:0xf bank_mask:0xf
    v_cndmask_b32_dpp v51, v223, v215, vcc quad_perm:[2,3,0,1] row_mask:0xf bank_mask:0xf
    v_mfma_f32_16x16x32_bf16 v[132:135], v[180:183], v[20:23], v[132:135]
    v_cndmask_b32_dpp v52, v224, v216, vcc quad_perm:[2,3,0,1] row_mask:0xf bank_mask:0xf
    v_cndmask_b32_dpp v53, v225, v217, vcc quad_perm:[2,3,0,1] row_mask:0xf bank_mask:0xf
    v_mfma_f32_16x16x32_bf16 v[148:151], v[180:183], v[36:39], v[148:151]
    v_cndmask_b32_dpp v54, v226, v218, vcc quad_perm:[2,3,0,1] row_mask:0xf bank_mask:0xf
    v_cndmask_b32_dpp v55, v227, v219, vcc quad_perm:[2,3,0,1] row_mask:0xf bank_mask:0xf
    s_not_b64 vcc, vcc
    buffer_load_dwordx4 v[112:115], v203, s[12:15], 0 offen offset:0
    v_mfma_f32_16x16x32_bf16 v[136:139], v[184:187], v[20:23], v[136:139]
    v_cndmask_b32_dpp v56, v212, v220, vcc quad_perm:[2,3,0,1] row_mask:0xf bank_mask:0xf
    v_cndmask_b32_dpp v57, v213, v221, vcc quad_perm:[2,3,0,1] row_mask:0xf bank_mask:0xf
    v_mfma_f32_16x16x32_bf16 v[152:155], v[184:187], v[36:39], v[152:155]
    v_cndmask_b32_dpp v58, v214, v222, vcc quad_perm:[2,3,0,1] row_mask:0xf bank_mask:0xf
    v_cndmask_b32_dpp v59, v215, v223, vcc quad_perm:[2,3,0,1] row_mask:0xf bank_mask:0xf
    v_mfma_f32_16x16x32_bf16 v[140:143], v[188:191], v[20:23], v[140:143]
    v_cndmask_b32_dpp v60, v216, v224, vcc quad_perm:[2,3,0,1] row_mask:0xf bank_mask:0xf
    v_cndmask_b32_dpp v61, v217, v225, vcc quad_perm:[2,3,0,1] row_mask:0xf bank_mask:0xf
    v_mfma_f32_16x16x32_bf16 v[156:159], v[188:191], v[36:39], v[156:159]
    v_cndmask_b32_dpp v62, v218, v226, vcc quad_perm:[2,3,0,1] row_mask:0xf bank_mask:0xf
    v_cndmask_b32_dpp v63, v219, v227, vcc quad_perm:[2,3,0,1] row_mask:0xf bank_mask:0xf
    s_mov_b32 vcc_lo, 0x55555555
    s_mov_b32 vcc_hi, 0x55555555
    buffer_load_dwordx4 v[116:119], v203, s[12:15], 0 offen offset:896
    ds_read_b128 v[176:179], v208 offset:0
    ds_read_b128 v[180:183], v208 offset:2048
    ds_read_b128 v[184:187], v208 offset:4096
    ds_read_b128 v[188:191], v208 offset:6144
    s_waitcnt lgkmcnt(4)
    v_mfma_f32_16x16x32_bf16 v[128:131], v[160:163], v[24:27], v[128:131]
    v_cndmask_b32_dpp v212, v68, v64, vcc quad_perm:[1,0,3,2] row_mask:0xf bank_mask:0xf
    v_cndmask_b32_dpp v213, v69, v65, vcc quad_perm:[1,0,3,2] row_mask:0xf bank_mask:0xf
    v_mfma_f32_16x16x32_bf16 v[144:147], v[160:163], v[40:43], v[144:147]
    v_cndmask_b32_dpp v214, v70, v66, vcc quad_perm:[1,0,3,2] row_mask:0xf bank_mask:0xf
    v_cndmask_b32_dpp v215, v71, v67, vcc quad_perm:[1,0,3,2] row_mask:0xf bank_mask:0xf
    v_mfma_f32_16x16x32_bf16 v[132:135], v[164:167], v[24:27], v[132:135]
    v_cndmask_b32_dpp v220, v76, v72, vcc quad_perm:[1,0,3,2] row_mask:0xf bank_mask:0xf
    v_cndmask_b32_dpp v221, v77, v73, vcc quad_perm:[1,0,3,2] row_mask:0xf bank_mask:0xf
    v_mfma_f32_16x16x32_bf16 v[148:151], v[164:167], v[40:43], v[148:151]
    v_cndmask_b32_dpp v222, v78, v74, vcc quad_perm:[1,0,3,2] row_mask:0xf bank_mask:0xf
    v_cndmask_b32_dpp v223, v79, v75, vcc quad_perm:[1,0,3,2] row_mask:0xf bank_mask:0xf
    s_not_b64 vcc, vcc
    buffer_load_dwordx4 v[120:123], v203, s[16:19], 0 offen offset:0
    v_mfma_f32_16x16x32_bf16 v[136:139], v[168:171], v[24:27], v[136:139]
    v_cndmask_b32_dpp v216, v64, v68, vcc quad_perm:[1,0,3,2] row_mask:0xf bank_mask:0xf
    v_cndmask_b32_dpp v217, v65, v69, vcc quad_perm:[1,0,3,2] row_mask:0xf bank_mask:0xf
    v_mfma_f32_16x16x32_bf16 v[152:155], v[168:171], v[40:43], v[152:155]
    v_cndmask_b32_dpp v218, v66, v70, vcc quad_perm:[1,0,3,2] row_mask:0xf bank_mask:0xf
    v_cndmask_b32_dpp v219, v67, v71, vcc quad_perm:[1,0,3,2] row_mask:0xf bank_mask:0xf
    v_mfma_f32_16x16x32_bf16 v[140:143], v[172:175], v[24:27], v[140:143]
    v_cndmask_b32_dpp v224, v72, v76, vcc quad_perm:[1,0,3,2] row_mask:0xf bank_mask:0xf
    v_cndmask_b32_dpp v225, v73, v77, vcc quad_perm:[1,0,3,2] row_mask:0xf bank_mask:0xf
    v_mfma_f32_16x16x32_bf16 v[156:159], v[172:175], v[40:43], v[156:159]
    v_cndmask_b32_dpp v226, v74, v78, vcc quad_perm:[1,0,3,2] row_mask:0xf bank_mask:0xf
    v_cndmask_b32_dpp v227, v75, v79, vcc quad_perm:[1,0,3,2] row_mask:0xf bank_mask:0xf
    s_mov_b32 vcc_lo, 0x33333333
    s_mov_b32 vcc_hi, 0x33333333
    buffer_load_dwordx4 v[124:127], v203, s[16:19], 0 offen offset:896
    ds_read_b128 v[160:163], v205 offset:16384
    ds_read_b128 v[164:167], v205 offset:18432
    ds_read_b128 v[168:171], v205 offset:20480
    ds_read_b128 v[172:175], v205 offset:22528
    s_waitcnt lgkmcnt(4)
    v_mfma_f32_16x16x32_bf16 v[128:131], v[176:179], v[28:31], v[128:131]
    v_cndmask_b32_dpp v64, v220, v212, vcc quad_perm:[2,3,0,1] row_mask:0xf bank_mask:0xf
    v_cndmask_b32_dpp v65, v221, v213, vcc quad_perm:[2,3,0,1] row_mask:0xf bank_mask:0xf
    v_mfma_f32_16x16x32_bf16 v[144:147], v[176:179], v[44:47], v[144:147]
    v_cndmask_b32_dpp v66, v222, v214, vcc quad_perm:[2,3,0,1] row_mask:0xf bank_mask:0xf
    v_cndmask_b32_dpp v67, v223, v215, vcc quad_perm:[2,3,0,1] row_mask:0xf bank_mask:0xf
    v_mfma_f32_16x16x32_bf16 v[132:135], v[180:183], v[28:31], v[132:135]
    v_cndmask_b32_dpp v68, v224, v216, vcc quad_perm:[2,3,0,1] row_mask:0xf bank_mask:0xf
    v_cndmask_b32_dpp v69, v225, v217, vcc quad_perm:[2,3,0,1] row_mask:0xf bank_mask:0xf
    v_mfma_f32_16x16x32_bf16 v[148:151], v[180:183], v[44:47], v[148:151]
    v_cndmask_b32_dpp v70, v226, v218, vcc quad_perm:[2,3,0,1] row_mask:0xf bank_mask:0xf
    v_cndmask_b32_dpp v71, v227, v219, vcc quad_perm:[2,3,0,1] row_mask:0xf bank_mask:0xf
    s_not_b64 vcc, vcc
    v_mfma_f32_16x16x32_bf16 v[136:139], v[184:187], v[28:31], v[136:139]
    v_cndmask_b32_dpp v72, v212, v220, vcc quad_perm:[2,3,0,1] row_mask:0xf bank_mask:0xf
    v_cndmask_b32_dpp v73, v213, v221, vcc quad_perm:[2,3,0,1] row_mask:0xf bank_mask:0xf
    v_mfma_f32_16x16x32_bf16 v[152:155], v[184:187], v[44:47], v[152:155]
    v_cndmask_b32_dpp v74, v214, v222, vcc quad_perm:[2,3,0,1] row_mask:0xf bank_mask:0xf
    v_cndmask_b32_dpp v75, v215, v223, vcc quad_perm:[2,3,0,1] row_mask:0xf bank_mask:0xf
    v_mfma_f32_16x16x32_bf16 v[140:143], v[188:191], v[28:31], v[140:143]
    v_cndmask_b32_dpp v76, v216, v224, vcc quad_perm:[2,3,0,1] row_mask:0xf bank_mask:0xf
    v_cndmask_b32_dpp v77, v217, v225, vcc quad_perm:[2,3,0,1] row_mask:0xf bank_mask:0xf
    v_mfma_f32_16x16x32_bf16 v[156:159], v[188:191], v[44:47], v[156:159]
    v_cndmask_b32_dpp v78, v218, v226, vcc quad_perm:[2,3,0,1] row_mask:0xf bank_mask:0xf
    v_cndmask_b32_dpp v79, v219, v227, vcc quad_perm:[2,3,0,1] row_mask:0xf bank_mask:0xf
    s_waitcnt vmcnt(7)
    s_barrier
    s_mov_b32 s61, 0
NL1:
    v_readfirstlane_b32 s60, v15
    s_nop 0
    s_cmp_lg_u32 s60, 0
    s_cbranch_scc1 ND1
    s_add_u32 s61, s61, 1
    s_cmp_gt_u32 s61, 100000
    s_cbranch_scc1 ND1
    buffer_load_dword v15, off, s[36:39], 0 sc1
    s_waitcnt vmcnt(0)
    s_branch NL1
ND1:
    s_nop 1
    buffer_store_dword v15, off, s[28:31], s55 sc1
    ds_read_b128 v[176:179], v206 offset:16384
    ds_read_b128 v[180:183], v206 offset:18432
    ds_read_b128 v[184:187], v206 offset:20480
    ds_read_b128 v[188:191], v206 offset:22528
    s_waitcnt lgkmcnt(4)
    v_mfma_f32_16x16x32_bf16 v[128:131], v[160:163], v[48:51], v[128:131]
    s_mov_b32 vcc_lo, 0x55555555
    s_mov_b32 vcc_hi, 0x55555555
    v_cndmask_b32_dpp v212, v84, v80, vcc quad_perm:[1,0,3,2] row_mask:0xf bank_mask:0xf
    v_cndmask_b32_dpp v213, v85, v81, vcc quad_perm:[1,0,3,2] row_mask:0xf bank_mask:0xf
    v_mfma_f32_16x16x32_bf16 v[144:147], v[160:163], v[64:67], v[144:147]
    v_cndmask_b32_dpp v214, v86, v82, vcc quad_perm:[1,0,3,2] row_mask:0xf bank_mask:0xf
    v_cndmask_b32_dpp v215, v87, v83, vcc quad_perm:[1,0,3,2] row_mask:0xf bank_mask:0xf
    v_mfma_f32_16x16x32_bf16 v[132:135], v[164:167], v[48:51], v[132:135]
    v_cndmask_b32_dpp v220, v92, v88, vcc quad_perm:[1,0,3,2] row_mask:0xf bank_mask:0xf
    v_cndmask_b32_dpp v221, v93, v89, vcc quad_perm:[1,0,3,2] row_mask:0xf bank_mask:0xf
    v_mfma_f32_16x16x32_bf16 v[148:151], v[164:167], v[64:67], v[148:151]
    v_cndmask_b32_dpp v222, v94, v90, vcc quad_perm:[1,0,3,2] row_mask:0xf bank_mask:0xf
    v_cndmask_b32_dpp v223, v95, v91, vcc quad_perm:[1,0,3,2] row_mask:0xf bank_mask:0xf
    s_not_b64 vcc, vcc
    v_mfma_f32_16x16x32_bf16 v[136:139], v[168:171], v[48:51], v[136:139]
    v_cndmask_b32_dpp v216, v80, v84, vcc quad_perm:[1,0,3,2] row_mask:0xf bank_mask:0xf
    v_cndmask_b32_dpp v217, v81, v85, vcc quad_perm:[1,0,3,2] row_mask:0xf bank_mask:0xf
    v_mfma_f32_16x16x32_bf16 v[152:155], v[168:171], v[64:67], v[152:155]
    v_cndmask_b32_dpp v218, v82, v86, vcc quad_perm:[1,0,3,2] row_mask:0xf bank_mask:0xf
    v_cndmask_b32_dpp v219, v83, v87, vcc quad_perm:[1,0,3,2] row_mask:0xf bank_mask:0xf
    v_mfma_f32_16x16x32_bf16 v[140:143], v[172:175], v[48:51], v[140:143]
    v_cndmask_b32_dpp v224, v88, v92, vcc quad_perm:[1,0,3,2] row_mask:0xf bank_mask:0xf
    v_cndmask_b32_dpp v225, v89, v93, vcc quad_perm:[1,0,3,2] row_mask:0xf bank_mask:0xf
    v_mfma_f32_16x16x32_bf16 v[156:159], v[172:175], v[64:67], v[156:159]
    v_cndmask_b32_dpp v226, v90, v94, vcc quad_perm:[1,0,3,2] row_mask:0xf bank_mask:0xf
    v_cndmask_b32_dpp v227, v91, v95, vcc quad_perm:[1,0,3,2] row_mask:0xf bank_mask:0xf
    s_mov_b32 vcc_lo, 0x33333333
    s_mov_b32 vcc_hi, 0x33333333
    ds_read_b128 v[160:163], v207 offset:16384
    ds_read_b128 v[164:167], v207 offset:18432
    ds_read_b128 v[168:171], v207 offset:20480
    ds_read_b128 v[172:175], v207 offset:22528
    s_waitcnt lgkmcnt(4)
    v_mfma_f32_16x16x32_bf16 v[128:131], v[176:179], v[52:55], v[128:131]
    v_cndmask_b32_dpp v80, v220, v212, vcc quad_perm:[2,3,0,1] row_mask:0xf bank_mask:0xf
    v_cndmask_b32_dpp v81, v221, v213, vcc quad_perm:[2,3,0,1] row_mask:0xf bank_mask:0xf
    v_mfma_f32_16x16x32_bf16 v[144:147], v[176:179], v[68:71], v[144:147]
    v_cndmask_b32_dpp v82, v222, v214, vcc quad_perm:[2,3,0,1] row_mask:0xf bank_mask:0xf
    v_cndmask_b32_dpp v83, v223, v215, vcc quad_perm:[2,3,0,1] row_mask:0xf bank_mask:0xf
    v_mfma_f32_16x16x32_bf16 v[132:135], v[180:183], v[52:55], v[132:135]
    v_cndmask_b32_dpp v84, v224, v216, vcc quad_perm:[2,3,0,1] row_mask:0xf bank_mask:0xf
    v_cndmask_b32_dpp v85, v225, v217, vcc quad_perm:[2,3,0,1] row_mask:0xf bank_mask:0xf
    v_mfma_f32_16x16x32_bf16 v[148:151], v[180:183], v[68:71], v[148:151]
    v_cndmask_b32_dpp v86, v226, v218, vcc quad_perm:[2,3,0,1] row_mask:0xf bank_mask:0xf
    v_cndmask_b32_dpp v87, v227, v219, vcc quad_perm:[2,3,0,1] row_mask:0xf bank_mask:0xf
    s_not_b64 vcc, vcc
    v_mfma_f32_16x16x32_bf16 v[136:139], v[184:187], v[52:55], v[136:139]
    v_cndmask_b32_dpp v88, v212, v220, vcc quad_perm:[2,3,0,1] row_mask:0xf bank_mask:0xf
    v_cndmask_b32_dpp v89, v213, v221, vcc quad_perm:[2,3,0,1] row_mask:0xf bank_mask:0xf
    v_mfma_f32_16x16x32_bf16 v[152:155], v[184:187], v[68:71], v[152:155]
    v_cndmask_b32_dpp v90, v214, v222, vcc quad_perm:[2,3,0,1] row_mask:0xf bank_mask:0xf
    v_cndmask_b32_dpp v91, v215, v223, vcc quad_perm:[2,3,0,1] row_mask:0xf bank_mask:0xf
    v_mfma_f32_16x16x32_bf16 v[140:143], v[188:191], v[52:55], v[140:143]
    v_cndmask_b32_dpp v92, v216, v224, vcc quad_perm:[2,3,0,1] row_mask:0xf bank_mask:0xf
    v_cndmask_b32_dpp v93, v217, v225, vcc quad_perm:[2,3,0,1] row_mask:0xf bank_mask:0xf
    v_mfma_f32_16x16x32_bf16 v[156:159], v[188:191], v[68:71], v[156:159]
    v_cndmask_b32_dpp v94, v218, v226, vcc quad_perm:[2,3,0,1] row_mask:0xf bank_mask:0xf
    v_cndmask_b32_dpp v95, v219, v227, vcc quad_perm:[2,3,0,1] row_mask:0xf bank_mask:0xf
    s_mov_b32 vcc_lo, 0x55555555
    s_mov_b32 vcc_hi, 0x55555555
    ds_read_b128 v[176:179], v208 offset:16384
    ds_read_b128 v[180:183], v208 offset:18432
    ds_read_b128 v[184:187], v208 offset:20480
    ds_read_b128 v[188:191], v208 offset:22528
    s_waitcnt lgkmcnt(4)
    v_mfma_f32_16x16x32_bf16 v[128:131], v[160:163], v[56:59], v[128:131]
    v_cndmask_b32_dpp v212, v100, v96, vcc quad_perm:[1,0,3,2] row_mask:0xf bank_mask:0xf
    v_cndmask_b32_dpp v213, v101, v97, vcc quad_perm:[1,0,3,2] row_mask:0xf bank_mask:0xf
    v_mfma_f32_16x16x32_bf16 v[144:147], v[160:163], v[72:75], v[144:147]
    v_cndmask_b32_dpp v214, v102, v98, vcc quad_perm:[1,0,3,2] row_mask:0xf bank_mask:0xf
    v_cndmask_b32_dpp v215, v103, v99, vcc quad_perm:[1,0,3,2] row_mask:0xf bank_mask:0xf
    v_mfma_f32_16x16x32_bf16 v[132:135], v[164:167], v[56:59], v[132:135]
    v_cndmask_b32_dpp v220, v108, v104, vcc quad_perm:[1,0,3,2] row_mask:0xf bank_mask:0xf
    v_cndmask_b32_dpp v221, v109, v105, vcc quad_perm:[1,0,3,2] row_mask:0xf bank_mask:0xf
    v_mfma_f32_16x16x32_bf16 v[148:151], v[164:167], v[72:75], v[148:151]
    v_cndmask_b32_dpp v222, v110, v106, vcc quad_perm:[1,0,3,2] row_mask:0xf bank_mask:0xf
    v_cndmask_b32_dpp v223, v111, v107, vcc quad_perm:[1,0,3,2] row_mask:0xf bank_mask:0xf
    s_not_b64 vcc, vcc
    v_mfma_f32_16x16x32_bf16 v[136:139], v[168:171], v[56:59], v[136:139]
    v_cndmask_b32_dpp v216, v96, v100, vcc quad_perm:[1,0,3,2] row_mask:0xf bank_mask:0xf
    v_cndmask_b32_dpp v217, v97, v101, vcc quad_perm:[1,0,3,2] row_mask:0xf bank_mask:0xf
    v_mfma_f32_16x16x32_bf16 v[152:155], v[168:171], v[72:75], v[152:155]
    v_cndmask_b32_dpp v218, v98, v102, vcc quad_perm:[1,0,3,2] row_mask:0xf bank_mask:0xf
    v_cndmask_b32_dpp v219, v99, v103, vcc quad_perm:[1,0,3,2] row_mask:0xf bank_mask:0xf
    v_mfma_f32_16x16x32_bf16 v[140:143], v[172:175], v[56:59], v[140:143]
    v_cndmask_b32_dpp v224, v104, v108, vcc quad_perm:[1,0,3,2] row_mask:0xf bank_mask:0xf
    v_cndmask_b32_dpp v225, v105, v109, vcc quad_perm:[1,0,3,2] row_mask:0xf bank_mask:0xf
    v_mfma_f32_16x16x32_bf16 v[156:159], v[172:175], v[72:75], v[156:159]
    v_cndmask_b32_dpp v226, v106, v110, vcc quad_perm:[1,0,3,2] row_mask:0xf bank_mask:0xf
    v_cndmask_b32_dpp v227, v107, v111, vcc quad_perm:[1,0,3,2] row_mask:0xf bank_mask:0xf
    s_mov_b32 vcc_lo, 0x33333333
    s_mov_b32 vcc_hi, 0x33333333
    ds_read_b128 v[160:163], v205 offset:32768
    ds_read_b128 v[164:167], v205 offset:34816
    ds_read_b128 v[168:171], v205 offset:36864
    ds_read_b128 v[172:175], v205 offset:38912
    s_waitcnt lgkmcnt(4)
    v_mfma_f32_16x16x32_bf16 v[128:131], v[176:179], v[60:63], v[128:131]
    v_cndmask_b32_dpp v96, v220, v212, vcc quad_perm:[2,3,0,1] row_mask:0xf bank_mask:0xf
    v_cndmask_b32_dpp v97, v221, v213, vcc quad_perm:[2,3,0,1] row_mask:0xf bank_mask:0xf
    v_mfma_f32_16x16x32_bf16 v[144:147], v[176:179], v[76:79], v[144:147]
    v_cndmask_b32_dpp v98, v222, v214, vcc quad_perm:[2,3,0,1] row_mask:0xf bank_mask:0xf
    v_cndmask_b32_dpp v99, v223, v215, vcc quad_perm:[2,3,0,1] row_mask:0xf bank_mask:0xf
    v_mfma_f32_16x16x32_bf16 v[132:135], v[180:183], v[60:63], v[132:135]
    v_cndmask_b32_dpp v100, v224, v216, vcc quad_perm:[2,3,0,1] row_mask:0xf bank_mask:0xf
    v_cndmask_b32_dpp v101, v225, v217, vcc quad_perm:[2,3,0,1] row_mask:0xf bank_mask:0xf
    v_mfma_f32_16x16x32_bf16 v[148:151], v[180:183], v[76:79], v[148:151]
    v_cndmask_b32_dpp v102, v226, v218, vcc quad_perm:[2,3,0,1] row_mask:0xf bank_mask:0xf
    v_cndmask_b32_dpp v103, v227, v219, vcc quad_perm:[2,3,0,1] row_mask:0xf bank_mask:0xf
    s_not_b64 vcc, vcc
    v_mfma_f32_16x16x32_bf16 v[136:139], v[184:187], v[60:63], v[136:139]
    v_cndmask_b32_dpp v104, v212, v220, vcc quad_perm:[2,3,0,1] row_mask:0xf bank_mask:0xf
    v_cndmask_b32_dpp v105, v213, v221, vcc quad_perm:[2,3,0,1] row_mask:0xf bank_mask:0xf
    v_mfma_f32_16x16x32_bf16 v[152:155], v[184:187], v[76:79], v[152:155]
    v_cndmask_b32_dpp v106, v214, v222, vcc quad_perm:[2,3,0,1] row_mask:0xf bank_mask:0xf
    v_cndmask_b32_dpp v107, v215, v223, vcc quad_perm:[2,3,0,1] row_mask:0xf bank_mask:0xf
    v_mfma_f32_16x16x32_bf16 v[140:143], v[188:191], v[60:63], v[140:143]
    v_cndmask_b32_dpp v108, v216, v224, vcc quad_perm:[2,3,0,1] row_mask:0xf bank_mask:0xf
    v_cndmask_b32_dpp v109, v217, v225, vcc quad_perm:[2,3,0,1] row_mask:0xf bank_mask:0xf
    v_mfma_f32_16x16x32_bf16 v[156:159], v[188:191], v[76:79], v[156:159]
    v_cndmask_b32_dpp v110, v218, v226, vcc quad_perm:[2,3,0,1] row_mask:0xf bank_mask:0xf
    v_cndmask_b32_dpp v111, v219, v227, vcc quad_perm:[2,3,0,1] row_mask:0xf bank_mask:0xf
    s_waitcnt vmcnt(1)
    s_barrier
    s_mov_b32 s61, 0
    s_branch PC2
PL2:
    buffer_load_dword v232, v6, s[28:31], 0 offen sc1
    s_waitcnt vmcnt(0)
PC2:
    v_cmp_ne_u32 vcc, s60, v232
    s_nop 4
    s_cbranch_vccz PD2
    s_add_u32 s61, s61, 1
    s_cmp_lt_u32 s61, 100000
    s_cbranch_scc1 PL2
PD2:
    ds_read_b128 v[176:179], v206 offset:32768
    ds_read_b128 v[180:183], v206 offset:34816
    ds_read_b128 v[184:187], v206 offset:36864
    ds_read_b128 v[188:191], v206 offset:38912
    s_waitcnt lgkmcnt(4)
    v_mfma_f32_16x16x32_bf16 v[128:131], v[160:163], v[80:83], v[128:131]
    s_mov_b32 vcc_lo, 0x55555555
    s_mov_b32 vcc_hi, 0x55555555
    v_cndmask_b32_dpp v212, v116, v112, vcc quad_perm:[1,0,3,2] row_mask:0xf bank_mask:0xf
    v_cndmask_b32_dpp v213, v117, v113, vcc quad_perm:[1,0,3,2] row_mask:0xf bank_mask:0xf
    v_mfma_f32_16x16x32_bf16 v[144:147], v[160:163], v[96:99], v[144:147]
    v_cndmask_b32_dpp v214, v118, v114, vcc quad_perm:[1,0,3,2] row_mask:0xf bank_mask:0xf
    v_cndmask_b32_dpp v215, v119, v115, vcc quad_perm:[1,0,3,2] row_mask:0xf bank_mask:0xf
    v_mfma_f32_16x16x32_bf16 v[132:135], v[164:167], v[80:83], v[132:135]
    v_cndmask_b32_dpp v220, v124, v120, vcc quad_perm:[1,0,3,2] row_mask:0xf bank_mask:0xf
    v_cndmask_b32_dpp v221, v125, v121, vcc quad_perm:[1,0,3,2] row_mask:0xf bank_mask:0xf
    v_mfma_f32_16x16x32_bf16 v[148:151], v[164:167], v[96:99], v[148:151]
    v_cndmask_b32_dpp v222, v126, v122, vcc quad_perm:[1,0,3,2] row_mask:0xf bank_mask:0xf
    v_cndmask_b32_dpp v223, v127, v123, vcc quad_perm:[1,0,3,2] row_mask:0xf bank_mask:0xf
    s_not_b64 vcc, vcc
    v_add_u32 v5, s48, v4
    buffer_load_dwordx4 v[16:19], v5, s[28:31], s44 offen sc1
    v_mfma_f32_16x16x32_bf16 v[136:139], v[168:171], v[80:83], v[136:139]
    v_cndmask_b32_dpp v216, v112, v116, vcc quad_perm:[1,0,3,2] row_mask:0xf bank_mask:0xf
    v_cndmask_b32_dpp v217, v113, v117, vcc quad_perm:[1,0,3,2] row_mask:0xf bank_mask:0xf
    v_mfma_f32_16x16x32_bf16 v[152:155], v[168:171], v[96:99], v[152:155]
    v_cndmask_b32_dpp v218, v114, v118, vcc quad_perm:[1,0,3,2] row_mask:0xf bank_mask:0xf
    v_cndmask_b32_dpp v219, v115, v119, vcc quad_perm:[1,0,3,2] row_mask:0xf bank_mask:0xf
    v_mfma_f32_16x16x32_bf16 v[140:143], v[172:175], v[80:83], v[140:143]
    v_cndmask_b32_dpp v224, v120, v124, vcc quad_perm:[1,0,3,2] row_mask:0xf bank_mask:0xf
    v_cndmask_b32_dpp v225, v121, v125, vcc quad_perm:[1,0,3,2] row_mask:0xf bank_mask:0xf
    v_mfma_f32_16x16x32_bf16 v[156:159], v[172:175], v[96:99], v[156:159]
    v_cndmask_b32_dpp v226, v122, v126, vcc quad_perm:[1,0,3,2] row_mask:0xf bank_mask:0xf
    v_cndmask_b32_dpp v227, v123, v127, vcc quad_perm:[1,0,3,2] row_mask:0xf bank_mask:0xf
    buffer_load_dwordx4 v[20:23], v5, s[28:31], s45 offen sc1
    ds_read_b128 v[160:163], v207 offset:32768
    ds_read_b128 v[164:167], v207 offset:34816
    ds_read_b128 v[168:171], v207 offset:36864
    ds_read_b128 v[172:175], v207 offset:38912
    s_waitcnt lgkmcnt(4)
    v_mfma_f32_16x16x32_bf16 v[128:131], v[176:179], v[84:87], v[128:131]
    v_lshlrev_b32 v228, 16, v228
    v_lshlrev_b32 v229, 16, v229
    v_mfma_f32_16x16x32_bf16 v[144:147], v[176:179], v[100:103], v[144:147]
    v_lshlrev_b32 v230, 16, v230
    v_lshlrev_b32 v14, 16, v14
    v_mfma_f32_16x16x32_bf16 v[132:135], v[180:183], v[84:87], v[132:135]
    v_mul_f32 v230, 0x3fb8aa3b, v230
    v_exp_f32 v230, v230
    v_mfma_f32_16x16x32_bf16 v[148:151], v[180:183], v[100:103], v[148:151]
    v_cvt_pk_bf16_f32 v230, v230, v230
    v_and_b32 v230, 0xffff0000, v230
    buffer_load_dwordx4 v[24:27], v5, s[28:31], s46 offen sc1
    v_mfma_f32_16x16x32_bf16 v[136:139], v[184:187], v[84:87], v[136:139]
    v_mul_f32 v250, v230, v228
    v_mul_f32 v251, v230, v229
    v_mfma_f32_16x16x32_bf16 v[152:155], v[184:187], v[100:103], v[152:155]
    v_mul_f32 v250, 0x3fb8aa3b, v250
    v_mul_f32 v251, 0x3e22f983, v251
    v_mfma_f32_16x16x32_bf16 v[140:143], v[188:191], v[84:87], v[140:143]
    v_mul_f32 v254, 1.0, v250
    v_mul_f32 v255, 1.0, v251
    v_mfma_f32_16x16x32_bf16 v[156:159], v[188:191], v[100:103], v[156:159]
    v_exp_f32 v254, v254
    v_fract_f32 v255, v255
    buffer_load_dwordx4 v[28:31], v5, s[28:31], s47 offen sc1
    ds_read_b128 v[176:179], v208 offset:32768
    ds_read_b128 v[180:183], v208 offset:34816
    ds_read_b128 v[184:187], v208 offset:36864
    ds_read_b128 v[188:191], v208 offset:38912
    s_waitcnt lgkmcnt(4)
    v_mfma_f32_16x16x32_bf16 v[128:131], v[160:163], v[88:91], v[128:131]
    v_cos_f32 v240, v255
    v_sin_f32 v241, v255
    v_mfma_f32_16x16x32_bf16 v[144:147], v[160:163], v[104:107], v[144:147]
    v_mul_f32 v240, v254, v240
    v_mul_f32 v241, v254, v241
    v_mfma_f32_16x16x32_bf16 v[132:135], v[164:167], v[88:91], v[132:135]
    v_mul_f32 v254, 0x41800000, v250
    v_mul_f32 v255, 0x41800000, v251
    v_mfma_f32_16x16x32_bf16 v[148:151], v[164:167], v[104:107], v[148:151]
    v_exp_f32 v254, v254
    v_fract_f32 v255, v255
    v_add_u32 v5, s49, v4
    buffer_load_dwordx4 v[32:35], v5, s[28:31], s44 offen sc1
    v_mfma_f32_16x16x32_bf16 v[136:139], v[168:171], v[88:91], v[136:139]
    v_cos_f32 v244, v255
    v_sin_f32 v245, v255
    v_mfma_f32_16x16x32_bf16 v[152:155], v[168:171], v[104:107], v[152:155]
    v_mul_f32 v244, v254, v244
    v_mul_f32 v245, v254, v245
    v_mfma_f32_16x16x32_bf16 v[140:143], v[172:175], v[88:91], v[140:143]
    v_mul_f32 v254, 0x42000000, v250
    v_mul_f32 v255, 0x42000000, v251
    v_mfma_f32_16x16x32_bf16 v[156:159], v[172:175], v[104:107], v[156:159]
    v_exp_f32 v254, v254
    v_fract_f32 v255, v255
    buffer_load_dwordx4 v[36:39], v5, s[28:31], s45 offen sc1
    ds_read_b128 v[160:163], v209 offset:49152
    ds_read_b128 v[164:167], v209 offset:51200
    ds_read_b128 v[168:171], v209 offset:53248
    ds_read_b128 v[172:175], v209 offset:55296
    s_waitcnt lgkmcnt(4)
    v_mfma_f32_16x16x32_bf16 v[128:131], v[176:179], v[92:95], v[128:131]
    v_cos_f32 v246, v255
    v_sin_f32 v247, v255
    v_mfma_f32_16x16x32_bf16 v[144:147], v[176:179], v[108:111], v[144:147]
    v_mul_f32 v246, v254, v246
    v_mul_f32 v247, v254, v247
    v_mfma_f32_16x16x32_bf16 v[132:135], v[180:183], v[92:95], v[132:135]
    v_sub_f32 v242, 0, v241
    v_cmp_le_u32 vcc, 1, v3
    v_mfma_f32_16x16x32_bf16 v[148:151], v[180:183], v[108:111], v[148:151]
    s_nop 0
    v_cndmask_b32 v243, 0, 1.0, vcc
    v_cmp_le_u32 vcc, 2, v3
    buffer_load_dwordx4 v[40:43], v5, s[28:31], s46 offen sc1
    v_mfma_f32_16x16x32_bf16 v[136:139], v[184:187], v[92:95], v[136:139]
    v_cndmask_b32 v244, 0, v244, vcc
    v_cndmask_b32 v245, 0, v245, vcc
    v_mfma_f32_16x16x32_bf16 v[152:155], v[184:187], v[108:111], v[152:155]
    v_cmp_le_u32 vcc, 3, v3
    s_nop 1
    v_cndmask_b32 v246, 0, v246, vcc
    v_mfma_f32_16x16x32_bf16 v[140:143], v[188:191], v[92:95], v[140:143]
    v_cndmask_b32 v247, 0, v247, vcc
    v_mul_f32 v230, v228, v228
    v_mfma_f32_16x16x32_bf16 v[156:159], v[188:191], v[108:111], v[156:159]
    v_fmac_f32 v230, v229, v229
    v_rcp_f32 v230, v230
    buffer_load_dwordx4 v[44:47], v5, s[28:31], s47 offen sc1
    ds_read_b128 v[176:179], v210 offset:49152
    ds_read_b128 v[180:183], v210 offset:51200
    ds_read_b128 v[184:187], v210 offset:53248
    ds_read_b128 v[188:191], v210 offset:55296
    s_waitcnt lgkmcnt(4)
    v_mfma_f32_16x16x32_bf16 v[128:131], v[160:163], v[212:215], v[128:131]
    v_add_f32 v231, -1.0, v240
    v_add_f32 v230, v230, v230
    v_mfma_f32_16x16x32_bf16 v[144:147], v[160:163], v[220:223], v[144:147]
    v_mul_f32 v248, v231, v228
    v_fmac_f32 v248, v241, v229
    v_add_u32 v5, s50, v4
    buffer_load_dwordx4 v[48:51], v5, s[28:31], s44 offen sc1
    v_mfma_f32_16x16x32_bf16 v[132:135], v[164:167], v[212:215], v[132:135]
    v_mul_f32 v249, v241, v228
    v_fma_f32 v249, -v231, v229, v249
    v_mfma_f32_16x16x32_bf16 v[148:151], v[164:167], v[220:223], v[148:151]
    v_mul_f32 v248, v248, v230
    v_mul_f32 v249, v249, v230
    buffer_load_dwordx4 v[52:55], v5, s[28:31], s45 offen sc1
    v_mfma_f32_16x16x32_bf16 v[136:139], v[168:171], v[212:215], v[136:139]
    v_mfma_f32_16x16x32_bf16 v[152:155], v[168:171], v[220:223], v[152:155]
    buffer_load_dwordx4 v[56:59], v5, s[28:31], s46 offen sc1
    v_mfma_f32_16x16x32_bf16 v[140:143], v[172:175], v[212:215], v[140:143]
    v_mfma_f32_16x16x32_bf16 v[156:159], v[172:175], v[220:223], v[156:159]
    buffer_load_dwordx4 v[60:63], v5, s[28:31], s47 offen sc1
    s_waitcnt lgkmcnt(0)
    v_mfma_f32_16x16x32_bf16 v[128:131], v[176:179], v[216:219], v[128:131]
    v_mfma_f32_16x16x32_bf16 v[144:147], v[176:179], v[224:227], v[144:147]
    v_add_u32 v5, s51, v4
    buffer_load_dwordx4 v[64:67], v5, s[28:31], s44 offen sc1
    v_mfma_f32_16x16x32_bf16 v[132:135], v[180:183], v[216:219], v[132:135]
    v_mfma_f32_16x16x32_bf16 v[148:151], v[180:183], v[224:227], v[148:151]
    buffer_load_dwordx4 v[68:71], v5, s[28:31], s45 offen sc1
    v_mfma_f32_16x16x32_bf16 v[136:139], v[184:187], v[216:219], v[136:139]
    v_mfma_f32_16x16x32_bf16 v[152:155], v[184:187], v[224:227], v[152:155]
    buffer_load_dwordx4 v[72:75], v5, s[28:31], s46 offen sc1
    v_mfma_f32_16x16x32_bf16 v[140:143], v[188:191], v[216:219], v[140:143]
    v_mfma_f32_16x16x32_bf16 v[156:159], v[188:191], v[224:227], v[156:159]
    buffer_load_dwordx4 v[76:79], v5, s[28:31], s47 offen sc1
    v_lshlrev_b32 v12, 2, v1
    v_subrev_u32 v13, 128, v12
    v_subrev_u32 v8, 192, v12
    v_subrev_u32 v12, 64, v12
    v_fmac_f32 v129, v240, v128
    v_fmac_f32 v145, v240, v144
    v_fmac_f32 v129, v242, v144
    v_fmac_f32 v145, v241, v128
    v_fmac_f32 v130, v240, v129
    v_fmac_f32 v146, v240, v145
    v_fmac_f32 v130, v242, v145
    v_fmac_f32 v146, v241, v129
    v_fmac_f32 v131, v240, v130
    v_fmac_f32 v147, v240, v146
    v_fmac_f32 v131, v242, v146
    v_fmac_f32 v147, v241, v130
    v_fmac_f32 v132, v240, v131
    v_fmac_f32 v148, v240, v147
    v_fmac_f32 v132, v242, v147
    v_fmac_f32 v148, v241, v131
    v_fmac_f32 v133, v240, v132
    v_fmac_f32 v149, v240, v148
    v_fmac_f32 v133, v242, v148
    v_fmac_f32 v149, v241, v132
    v_fmac_f32 v134, v240, v133
    v_fmac_f32 v150, v240, v149
    v_fmac_f32 v134, v242, v149
    v_fmac_f32 v150, v241, v133
    v_fmac_f32 v135, v240, v134
    v_fmac_f32 v151, v240, v150
    v_fmac_f32 v135, v242, v150
    v_fmac_f32 v151, v241, v134
    v_fmac_f32 v136, v240, v135
    v_fmac_f32 v152, v240, v151
    v_fmac_f32 v136, v242, v151
    v_fmac_f32 v152, v241, v135
    v_fmac_f32 v137, v240, v136
    v_fmac_f32 v153, v240, v152
    v_fmac_f32 v137, v242, v152
    v_fmac_f32 v153, v241, v136
    v_fmac_f32 v138, v240, v137
    v_fmac_f32 v154, v240, v153
    v_fmac_f32 v138, v242, v153
    v_fmac_f32 v154, v241, v137
    v_fmac_f32 v139, v240, v138
    v_fmac_f32 v155, v240, v154
    v_fmac_f32 v139, v242, v154
    v_fmac_f32 v155, v241, v138
    v_fmac_f32 v140, v240, v139
    v_fmac_f32 v156, v240, v155
    v_fmac_f32 v140, v242, v155
    v_fmac_f32 v156, v241, v139
    v_fmac_f32 v141, v240, v140
    v_fmac_f32 v157, v240, v156
    v_fmac_f32 v141, v242, v156
    v_fmac_f32 v157, v241, v140
    v_fmac_f32 v142, v240, v141
    v_fmac_f32 v158, v240, v157
    v_fmac_f32 v142, v242, v157
    v_fmac_f32 v158, v241, v141
    v_fmac_f32 v143, v240, v142
    v_fmac_f32 v159, v240, v158
    v_fmac_f32 v143, v242, v158
    v_fmac_f32 v159, v241, v142
    ds_bpermute_b32 v160, v12, v143
    ds_bpermute_b32 v161, v12, v159
    ds_bpermute_b32 v162, v13, v143
    ds_bpermute_b32 v163, v13, v159
    ds_bpermute_b32 v164, v8, v143
    ds_bpermute_b32 v165, v8, v159
    s_lshl_b32 s6, s67, 8
    s_add_u32 s6, s6, 1835008
    v_lshlrev_b32 v12, 4, v2
    v_mov_b32 v169, s60
    v_mov_b32 v171, s60
    s_waitcnt lgkmcnt(0)
    v_mul_f32 v252, v243, v160
    v_mul_f32 v253, v243, v161
    v_fmac_f32 v252, v244, v162
    v_fmac_f32 v253, v244, v163
    v_fma_f32 v252, -v245, v163, v252
    v_fmac_f32 v253, v245, v162
    v_fmac_f32 v252, v246, v164
    v_fmac_f32 v253, v246, v165
    v_fma_f32 v252, -v247, v165, v252
    v_fmac_f32 v253, v247, v164
    v_fma_f32 v168, v244, v252, v143
    v_fma_f32 v170, v244, v253, v159
    v_fma_f32 v168, -v245, v253, v168
    v_fmac_f32 v170, v245, v252
    s_mov_b32 exec_lo, 0
    s_mov_b32 exec_hi, 0xffff0000
    buffer_store_dwordx4 v[168:171], v12, s[28:31], s6 offen sc1
    s_mov_b64 exec, -1
    v_lshlrev_b32 v8, 6, v3
    s_lshl_b32 s68, s64, 9
    s_add_u32 s68, s68, 1835008
    v_lshl_add_u32 v12, v3, 11, v12
    v_pk_mul_f32 v[254:255], v[248:249], v[240:241] op_sel:[0,0] op_sel_hi:[0,1]
    v_pk_fma_f32 v[160:161], v[248:249], v[240:241], v[254:255] op_sel:[1,1,0] op_sel_hi:[1,0,1] neg_lo:[0,1,0]
    v_mul_f32 v13, v249, v144
    v_mul_f32 v144, v248, v144
    v_fmac_f32 v144, v249, v128
    v_fma_f32 v128, v248, v128, -v13
    v_pk_mul_f32 v[254:255], v[160:161], v[240:241] op_sel:[0,0] op_sel_hi:[0,1]
    v_mul_f32 v13, v249, v145
    v_mul_f32 v145, v248, v145
    v_pk_fma_f32 v[162:163], v[160:161], v[240:241], v[254:255] op_sel:[1,1,0] op_sel_hi:[1,0,1] neg_lo:[0,1,0]
    v_fmac_f32 v145, v249, v129
    v_fma_f32 v129, v248, v129, -v13
    v_pk_mul_f32 v[254:255], v[162:163], v[240:241] op_sel:[0,0] op_sel_hi:[0,1]
    v_mul_f32 v13, v249, v146
    v_mul_f32 v146, v248, v146
    v_pk_fma_f32 v[164:165], v[162:163], v[240:241], v[254:255] op_sel:[1,1,0] op_sel_hi:[1,0,1] neg_lo:[0,1,0]
    v_fmac_f32 v146, v249, v130
    v_fma_f32 v130, v248, v130, -v13
    v_pk_mul_f32 v[254:255], v[164:165], v[240:241] op_sel:[0,0] op_sel_hi:[0,1]
    v_mul_f32 v13, v249, v147
    v_mul_f32 v147, v248, v147
    v_pk_fma_f32 v[166:167], v[164:165], v[240:241], v[254:255] op_sel:[1,1,0] op_sel_hi:[1,0,1] neg_lo:[0,1,0]
    v_fmac_f32 v147, v249, v131
    v_fma_f32 v131, v248, v131, -v13
    v_pk_mul_f32 v[254:255], v[166:167], v[240:241] op_sel:[0,0] op_sel_hi:[0,1]
    v_mul_f32 v13, v249, v148
    v_mul_f32 v148, v248, v148
    v_pk_fma_f32 v[168:169], v[166:167], v[240:241], v[254:255] op_sel:[1,1,0] op_sel_hi:[1,0,1] neg_lo:[0,1,0]
    v_fmac_f32 v148, v249, v132
    v_fma_f32 v132, v248, v132, -v13
    v_pk_mul_f32 v[254:255], v[168:169], v[240:241] op_sel:[0,0] op_sel_hi:[0,1]
    v_mul_f32 v13, v249, v149
    v_mul_f32 v149, v248, v149
    v_pk_fma_f32 v[170:171], v[168:169], v[240:241], v[254:255] op_sel:[1,1,0] op_sel_hi:[1,0,1] neg_lo:[0,1,0]
    v_fmac_f32 v149, v249, v133
    v_fma_f32 v133, v248, v133, -v13
    v_pk_mul_f32 v[254:255], v[170:171], v[240:241] op_sel:[0,0] op_sel_hi:[0,1]
    v_mul_f32 v13, v249, v150
    v_mul_f32 v150, v248, v150
    v_pk_fma_f32 v[172:173], v[170:171], v[240:241], v[254:255] op_sel:[1,1,0] op_sel_hi:[1,0,1] neg_lo:[0,1,0]
    v_fmac_f32 v150, v249, v134
    v_fma_f32 v134, v248, v134, -v13
    v_pk_mul_f32 v[254:255], v[172:173], v[240:241] op_sel:[0,0] op_sel_hi:[0,1]
    v_mul_f32 v13, v249, v151
    v_mul_f32 v151, v248, v151
    v_pk_fma_f32 v[174:175], v[172:173], v[240:241], v[254:255] op_sel:[1,1,0] op_sel_hi:[1,0,1] neg_lo:[0,1,0]
    v_fmac_f32 v151, v249, v135
    v_fma_f32 v135, v248, v135, -v13
    v_pk_mul_f32 v[254:255], v[174:175], v[240:241] op_sel:[0,0] op_sel_hi:[0,1]
    v_mul_f32 v13, v249, v152
    v_mul_f32 v152, v248, v152
    v_pk_fma_f32 v[176:177], v[174:175], v[240:241], v[254:255] op_sel:[1,1,0] op_sel_hi:[1,0,1] neg_lo:[0,1,0]
    v_fmac_f32 v152, v249, v136
    v_fma_f32 v136, v248, v136, -v13
    v_pk_mul_f32 v[254:255], v[176:177], v[240:241] op_sel:[0,0] op_sel_hi:[0,1]
    v_mul_f32 v13, v249, v153
    v_mul_f32 v153, v248, v153
    v_pk_fma_f32 v[178:179], v[176:177], v[240:241], v[254:255] op_sel:[1,1,0] op_sel_hi:[1,0,1] neg_lo:[0,1,0]
    v_fmac_f32 v153, v249, v137
    v_fma_f32 v137, v248, v137, -v13
    v_pk_mul_f32 v[254:255], v[178:179], v[240:241] op_sel:[0,0] op_sel_hi:[0,1]
    v_mul_f32 v13, v249, v154
    v_mul_f32 v154, v248, v154
    v_pk_fma_f32 v[180:181], v[178:179], v[240:241], v[254:255] op_sel:[1,1,0] op_sel_hi:[1,0,1] neg_lo:[0,1,0]
    v_fmac_f32 v154, v249, v138
    v_fma_f32 v138, v248, v138, -v13
    v_pk_mul_f32 v[254:255], v[180:181], v[240:241] op_sel:[0,0] op_sel_hi:[0,1]
    v_mul_f32 v13, v249, v155
    v_mul_f32 v155, v248, v155
    v_pk_fma_f32 v[182:183], v[180:181], v[240:241], v[254:255] op_sel:[1,1,0] op_sel_hi:[1,0,1] neg_lo:[0,1,0]
    v_fmac_f32 v155, v249, v139
    v_fma_f32 v139, v248, v139, -v13
    v_pk_mul_f32 v[254:255], v[182:183], v[240:241] op_sel:[0,0] op_sel_hi:[0,1]
    v_mul_f32 v13, v249, v156
    v_mul_f32 v156, v248, v156
    v_pk_fma_f32 v[184:185], v[182:183], v[240:241], v[254:255] op_sel:[1,1,0] op_sel_hi:[1,0,1] neg_lo:[0,1,0]
    v_fmac_f32 v156, v249, v140
    v_fma_f32 v140, v248, v140, -v13
    v_pk_mul_f32 v[254:255], v[184:185], v[240:241] op_sel:[0,0] op_sel_hi:[0,1]
    v_mul_f32 v13, v249, v157
    v_mul_f32 v157, v248, v157
    v_pk_fma_f32 v[186:187], v[184:185], v[240:241], v[254:255] op_sel:[1,1,0] op_sel_hi:[1,0,1] neg_lo:[0,1,0]
    v_fmac_f32 v157, v249, v141
    v_fma_f32 v141, v248, v141, -v13
    v_pk_mul_f32 v[254:255], v[186:187], v[240:241] op_sel:[0,0] op_sel_hi:[0,1]
    v_mul_f32 v13, v249, v158
    v_mul_f32 v158, v248, v158
    v_pk_fma_f32 v[188:189], v[186:187], v[240:241], v[254:255] op_sel:[1,1,0] op_sel_hi:[1,0,1] neg_lo:[0,1,0]
    v_fmac_f32 v158, v249, v142
    v_fma_f32 v142, v248, v142, -v13
    v_pk_mul_f32 v[254:255], v[188:189], v[240:241] op_sel:[0,0] op_sel_hi:[0,1]
    v_mul_f32 v13, v249, v159
    v_mul_f32 v159, v248, v159
    v_pk_fma_f32 v[190:191], v[188:189], v[240:241], v[254:255] op_sel:[1,1,0] op_sel_hi:[1,0,1] neg_lo:[0,1,0]
    v_fmac_f32 v159, v249, v143
    v_fma_f32 v143, v248, v143, -v13
    s_waitcnt lgkmcnt(0)
    v_lshlrev_b32 v13, 3, v3
    v_sub_u32 v13, s4, v13
    v_mov_b32 v10, 0x42800000
    v_subrev_u32 v192, 0, v13
    v_cvt_f32_i32 v193, v192
    v_cvt_f32_i32_e64 v192, v192 clamp
    v_fma_f32 v193, v193, v10, -v10
    v_mul_f32 v193, v192, v193
    v_subrev_u32 v196, 1, v13
    v_cvt_f32_i32 v197, v196
    v_cvt_f32_i32_e64 v196, v196 clamp
    v_fma_f32 v197, v197, v10, -v10
    v_mul_f32 v197, v196, v197
    v_subrev_u32 v200, 2, v13
    v_cvt_f32_i32 v201, v200
    v_cvt_f32_i32_e64 v200, v200 clamp
    v_fma_f32 v201, v201, v10, -v10
    v_mul_f32 v201, v200, v201
    v_subrev_u32 v204, 3, v13
    v_cvt_f32_i32 v205, v204
    v_cvt_f32_i32_e64 v204, v204 clamp
    v_fma_f32 v205, v205, v10, -v10
    v_mul_f32 v205, v204, v205
    v_subrev_u32 v208, 4, v13
    v_cvt_f32_i32 v209, v208
    v_cvt_f32_i32_e64 v208, v208 clamp
    v_fma_f32 v209, v209, v10, -v10
    v_mul_f32 v209, v208, v209
    v_subrev_u32 v212, 5, v13
    v_cvt_f32_i32 v213, v212
    v_cvt_f32_i32_e64 v212, v212 clamp
    v_fma_f32 v213, v213, v10, -v10
    v_mul_f32 v213, v212, v213
    v_subrev_u32 v216, 6, v13
    v_cvt_f32_i32 v217, v216
    v_cvt_f32_i32_e64 v216, v216 clamp
    v_fma_f32 v217, v217, v10, -v10
    v_mul_f32 v217, v216, v217
    v_subrev_u32 v220, 7, v13
    v_cvt_f32_i32 v221, v220
    v_cvt_f32_i32_e64 v220, v220 clamp
    v_fma_f32 v221, v221, v10, -v10
    v_mul_f32 v221, v220, v221
    v_mul_f32 v194, v193, v250
    v_mul_f32 v195, v193, v251
    v_mul_f32 v198, v197, v250
    v_mul_f32 v199, v197, v251
    v_mul_f32 v202, v201, v250
    v_mul_f32 v203, v201, v251
    v_mul_f32 v206, v205, v250
    v_mul_f32 v207, v205, v251
    v_mul_f32 v210, v209, v250
    v_mul_f32 v211, v209, v251
    v_mul_f32 v214, v213, v250
    v_mul_f32 v215, v213, v251
    v_mul_f32 v218, v217, v250
    v_mul_f32 v219, v217, v251
    v_mul_f32 v222, v221, v250
    v_mul_f32 v223, v221, v251
    v_exp_f32 v194, v194
    v_fract_f32 v195, v195
    v_exp_f32 v198, v198
    v_fract_f32 v199, v199
    v_exp_f32 v202, v202
    v_fract_f32 v203, v203
    v_exp_f32 v206, v206
    v_fract_f32 v207, v207
    v_exp_f32 v210, v210
    v_fract_f32 v211, v211
    v_exp_f32 v214, v214
    v_fract_f32 v215, v215
    v_exp_f32 v218, v218
    v_fract_f32 v219, v219
    v_exp_f32 v222, v222
    v_fract_f32 v223, v223
    v_cos_f32 v224, v195
    v_sin_f32 v225, v195
    v_mul_f32 v194, v192, v194
    v_cos_f32 v226, v199
    v_sin_f32 v227, v199
    v_mul_f32 v198, v196, v198
    v_cos_f32 v228, v203
    v_sin_f32 v229, v203
    v_mul_f32 v202, v200, v202
    v_cos_f32 v230, v207
    v_sin_f32 v231, v207
    v_mul_f32 v206, v204, v206
    v_cos_f32 v232, v211
    v_sin_f32 v233, v211
    v_mul_f32 v210, v208, v210
    v_cos_f32 v234, v215
    v_sin_f32 v235, v215
    v_mul_f32 v214, v212, v214
    v_cos_f32 v236, v219
    v_sin_f32 v237, v219
    v_mul_f32 v218, v216, v218
    v_cos_f32 v238, v223
    v_sin_f32 v239, v223
    v_mul_f32 v222, v220, v222
    v_pk_mul_f32 v[224:225], v[224:225], v[194:195] op_sel_hi:[1,0]
    v_pk_mul_f32 v[226:227], v[226:227], v[198:199] op_sel_hi:[1,0]
    v_pk_mul_f32 v[228:229], v[228:229], v[202:203] op_sel_hi:[1,0]
    v_pk_mul_f32 v[230:231], v[230:231], v[206:207] op_sel_hi:[1,0]
    v_pk_mul_f32 v[232:233], v[232:233], v[210:211] op_sel_hi:[1,0]
    v_pk_mul_f32 v[234:235], v[234:235], v[214:215] op_sel_hi:[1,0]
    v_pk_mul_f32 v[236:237], v[236:237], v[218:219] op_sel_hi:[1,0]
    v_pk_mul_f32 v[238:239], v[238:239], v[222:223] op_sel_hi:[1,0]
    v_lshlrev_b32 v10, 4, v3
    v_cvt_f32_i32 v10, v10
    v_mul_f32 v254, v10, v250
    v_mul_f32 v255, v10, v251
    v_exp_f32 v254, v254
    v_fract_f32 v255, v255
    v_cos_f32 v244, v255
    v_sin_f32 v245, v255
    v_mul_f32 v244, v254, v244
    v_mul_f32 v245, v254, v245
    v_lshrrev_b32 v6, 2, v2
    v_mul_u32_u24 v6, 272, v6
    v_and_b32 v13, 3, v2
    v_lshl_add_u32 v6, v13, 2, v6
    s_mul_i32 s62, s3, 3328
    s_add_u32 s62, s62, 68608
    v_add3_u32 v6, v6, v8, s62
    s_mov_b32 s61, 0
B_ST:
    buffer_load_dwordx4 v[192:195], v12, s[28:31], s68 offen offset:0 sc1
    buffer_load_dwordx4 v[196:199], v12, s[28:31], s68 offen offset:256 sc1
    buffer_load_dwordx4 v[200:203], v12, s[28:31], s68 offen offset:512 sc1
    buffer_load_dwordx4 v[204:207], v12, s[28:31], s68 offen offset:768 sc1
    buffer_load_dwordx4 v[208:211], v12, s[28:31], s68 offen offset:1024 sc1
    buffer_load_dwordx4 v[212:215], v12, s[28:31], s68 offen offset:1280 sc1
    buffer_load_dwordx4 v[216:219], v12, s[28:31], s68 offen offset:1536 sc1
    buffer_load_dwordx4 v[220:223], v12, s[28:31], s68 offen offset:1792 sc1
    s_waitcnt vmcnt(0)
    v_min_u32 v10, v193, v195
    v_max_u32 v13, v193, v195
    v_min3_u32 v10, v10, v197, v199
    v_max3_u32 v13, v13, v197, v199
    v_min3_u32 v10, v10, v201, v203
    v_max3_u32 v13, v13, v201, v203
    v_min3_u32 v10, v10, v205, v207
    v_max3_u32 v13, v13, v205, v207
    v_min3_u32 v10, v10, v209, v211
    v_max3_u32 v13, v13, v209, v211
    v_min3_u32 v10, v10, v213, v215
    v_max3_u32 v13, v13, v213, v215
    v_min3_u32 v10, v10, v217, v219
    v_max3_u32 v13, v13, v217, v219
    v_min3_u32 v10, v10, v221, v223
    v_max3_u32 v13, v13, v221, v223
    v_cmp_ne_u32 vcc, s60, v10
    v_cmp_ne_u32 s[6:7], s60, v13
    s_nop 0
    s_or_b64 vcc, vcc, s[6:7]
    s_nop 1
    s_cbranch_vccz B_STD
    s_add_u32 s61, s61, 1
    s_cmp_lt_u32 s61, 100000
    s_cbranch_scc1 B_ST
B_STD:
    v_mul_f32 v246, v224, v192
    v_mul_f32 v247, v224, v194
    v_mul_f32 v254, v225, v194
    v_mul_f32 v255, v225, v192
    v_fmac_f32 v246, v226, v196
    v_fmac_f32 v247, v226, v198
    v_fmac_f32 v254, v227, v198
    v_fmac_f32 v255, v227, v196
    v_fmac_f32 v246, v228, v200
    v_fmac_f32 v247, v228, v202
    v_fmac_f32 v254, v229, v202
    v_fmac_f32 v255, v229, v200
    v_fmac_f32 v246, v230, v204
    v_fmac_f32 v247, v230, v206
    v_fmac_f32 v254, v231, v206
    v_fmac_f32 v255, v231, v204
    v_fmac_f32 v246, v232, v208
    v_fmac_f32 v247, v232, v210
    v_fmac_f32 v254, v233, v210
    v_fmac_f32 v255, v233, v208
    v_fmac_f32 v246, v234, v212
    v_fmac_f32 v247, v234, v214
    v_fmac_f32 v254, v235, v214
    v_fmac_f32 v255, v235, v212
    v_fmac_f32 v246, v236, v216
    v_fmac_f32 v247, v236, v218
    v_fmac_f32 v254, v237, v218
    v_fmac_f32 v255, v237, v216
    v_fmac_f32 v246, v238, v220
    v_fmac_f32 v247, v238, v222
    v_fmac_f32 v254, v239, v222
    v_fmac_f32 v255, v239, v220
    v_sub_f32 v246, v246, v254
    v_add_f32 v247, v247, v255
    v_mov_b32 v254, v246
    v_mov_b32 v255, v247
    s_nop 0
    v_permlane32_swap_b32 v246, v254
    v_permlane32_swap_b32 v247, v255
    v_add_f32 v246, v246, v254
    v_add_f32 v247, v247, v255
    v_mov_b32 v254, v246
    v_mov_b32 v255, v247
    s_nop 0
    v_permlane16_swap_b32 v246, v254
    v_permlane16_swap_b32 v247, v255
    v_add_f32 v246, v246, v254
    v_add_f32 v247, v247, v255
    v_fmac_f32 v252, v244, v246
    v_fmac_f32 v253, v244, v247
    v_fma_f32 v252, -v245, v247, v252
    v_fmac_f32 v253, v245, v246
    v_sub_f32 v254, 0, v253
    v_fmac_f32 v128, v160, v252
    v_fmac_f32 v144, v160, v253
    v_fmac_f32 v128, v161, v254
    v_fmac_f32 v144, v161, v252
    v_fmac_f32 v129, v162, v252
    v_fmac_f32 v145, v162, v253
    v_fmac_f32 v129, v163, v254
    v_fmac_f32 v145, v163, v252
    v_fmac_f32 v130, v164, v252
    v_fmac_f32 v146, v164, v253
    v_fmac_f32 v130, v165, v254
    v_fmac_f32 v146, v165, v252
    v_fmac_f32 v131, v166, v252
    v_fmac_f32 v147, v166, v253
    v_fmac_f32 v131, v167, v254
    v_fmac_f32 v147, v167, v252
    v_fmac_f32 v132, v168, v252
    v_fmac_f32 v148, v168, v253
    v_fmac_f32 v132, v169, v254
    v_fmac_f32 v148, v169, v252
    v_fmac_f32 v133, v170, v252
    v_fmac_f32 v149, v170, v253
    v_fmac_f32 v133, v171, v254
    v_fmac_f32 v149, v171, v252
    v_fmac_f32 v134, v172, v252
    v_fmac_f32 v150, v172, v253
    v_fmac_f32 v134, v173, v254
    v_fmac_f32 v150, v173, v252
    v_fmac_f32 v135, v174, v252
    v_fmac_f32 v151, v174, v253
    v_fmac_f32 v135, v175, v254
    v_fmac_f32 v151, v175, v252
    v_fmac_f32 v136, v176, v252
    v_fmac_f32 v152, v176, v253
    v_fmac_f32 v136, v177, v254
    v_fmac_f32 v152, v177, v252
    v_fmac_f32 v137, v178, v252
    v_fmac_f32 v153, v178, v253
    v_fmac_f32 v137, v179, v254
    v_fmac_f32 v153, v179, v252
    v_fmac_f32 v138, v180, v252
    v_fmac_f32 v154, v180, v253
    v_fmac_f32 v138, v181, v254
    v_fmac_f32 v154, v181, v252
    v_fmac_f32 v139, v182, v252
    v_fmac_f32 v155, v182, v253
    v_fmac_f32 v139, v183, v254
    v_fmac_f32 v155, v183, v252
    v_fmac_f32 v140, v184, v252
    v_fmac_f32 v156, v184, v253
    v_fmac_f32 v140, v185, v254
    v_fmac_f32 v156, v185, v252
    v_fmac_f32 v141, v186, v252
    v_fmac_f32 v157, v186, v253
    v_fmac_f32 v141, v187, v254
    v_fmac_f32 v157, v187, v252
    v_fmac_f32 v142, v188, v252
    v_fmac_f32 v158, v188, v253
    v_fmac_f32 v142, v189, v254
    v_fmac_f32 v158, v189, v252
    v_fmac_f32 v143, v190, v252
    v_fmac_f32 v159, v190, v253
    v_fmac_f32 v143, v191, v254
    v_fmac_f32 v159, v191, v252
    v_lshl_add_u32 v13, v3, 4, v9
    v_add_u32 v13, s62, v13
    v_cvt_pk_bf16_f32 v128, v128, -v144
    v_cvt_pk_bf16_f32 v129, v129, -v145
    ds_write_b32 v6, v128 offset:0
    v_cvt_pk_bf16_f32 v130, v130, -v146
    ds_write_b32 v6, v129 offset:16
    v_cvt_pk_bf16_f32 v131, v131, -v147
    ds_write_b32 v6, v130 offset:32
    v_cvt_pk_bf16_f32 v132, v132, -v148
    ds_write_b32 v6, v131 offset:48
    v_cvt_pk_bf16_f32 v133, v133, -v149
    ds_write_b32 v6, v132 offset:1088
    v_cvt_pk_bf16_f32 v134, v134, -v150
    ds_write_b32 v6, v133 offset:1104
    v_cvt_pk_bf16_f32 v135, v135, -v151
    ds_write_b32 v6, v134 offset:1120
    v_cvt_pk_bf16_f32 v136, v136, -v152
    ds_write_b32 v6, v135 offset:1136
    ds_read_b128 v[192:195], v13 offset:0
    ds_read_b128 v[196:199], v13 offset:1088
    v_cvt_pk_bf16_f32 v137, v137, -v153
    ds_write_b32 v6, v136 offset:0
    v_cvt_pk_bf16_f32 v138, v138, -v154
    ds_write_b32 v6, v137 offset:16
    v_cvt_pk_bf16_f32 v139, v139, -v155
    ds_write_b32 v6, v138 offset:32
    v_cvt_pk_bf16_f32 v140, v140, -v156
    ds_write_b32 v6, v139 offset:48
    v_cvt_pk_bf16_f32 v141, v141, -v157
    ds_write_b32 v6, v140 offset:1088
    v_cvt_pk_bf16_f32 v142, v142, -v158
    ds_write_b32 v6, v141 offset:1104
    v_cvt_pk_bf16_f32 v143, v143, -v159
    ds_write_b32 v6, v142 offset:1120
    ds_write_b32 v6, v143 offset:1136
    ds_read_b128 v[200:203], v13 offset:0
    ds_read_b128 v[204:207], v13 offset:1088
    s_mul_i32 s68, s4, 114688
    s_add_u32 s68, s68, 3407872
    s_add_u32 s69, s68, 28672
    s_add_u32 s70, s68, 57344
    s_add_u32 s71, s68, 86016
    s_lshl_b32 s6, s64, 6
    v_add_u32 v6, s6, v9
    s_waitcnt lgkmcnt(11)
    buffer_store_dwordx4 v[192:195], v6, s[28:31], s68 offen sc1
    s_waitcnt lgkmcnt(10)
    buffer_store_dwordx4 v[196:199], v6, s[28:31], s69 offen sc1
    s_waitcnt lgkmcnt(1)
    buffer_store_dwordx4 v[200:203], v6, s[28:31], s70 offen sc1
    s_waitcnt lgkmcnt(0)
    buffer_store_dwordx4 v[204:207], v6, s[28:31], s71 offen sc1
    s_lshl_b32 s6, s4, 5
    s_lshr_b32 s7, s64, 4
    s_add_u32 s6, s6, s7
    s_lshl_b32 s6, s6, 7
    s_add_u32 s62, s6, 3014656
    v_min_u32 v10, 6, v1
    s_lshl_b32 s6, s4, 5
    s_mul_i32 s7, s3, 7
    s_add_u32 s6, s6, s7
    v_add_u32 v10, s6, v10
    v_lshlrev_b32 v10, 7, v10
    v_add_u32 v10, 3014656, v10
    s_lshr_b32 s6, s4, 4
    v_add_u32 v12, s6, v7
    v_lshlrev_b32 v12, 7, v12
    v_add_u32 v12, 3145728, v12
    v_add_u32 v13, s66, v9
    s_waitcnt vmcnt(0)
    buffer_store_dword v15, off, s[28:31], s62 sc1
    s_setprio 0
    v_add_u32 v5, s52, v4
    buffer_load_dwordx4 v[80:83], v5, s[28:31], s44 offen sc1
    buffer_load_dwordx4 v[84:87], v5, s[28:31], s45 offen sc1
    buffer_load_dwordx4 v[88:91], v5, s[28:31], s46 offen sc1
    buffer_load_dwordx4 v[92:95], v5, s[28:31], s47 offen sc1
    v_add_u32 v5, s53, v4
    buffer_load_dwordx4 v[96:99], v5, s[28:31], s44 offen sc1
    buffer_load_dwordx4 v[100:103], v5, s[28:31], s45 offen sc1
    buffer_load_dwordx4 v[104:107], v5, s[28:31], s46 offen sc1
    buffer_load_dwordx4 v[108:111], v5, s[28:31], s47 offen sc1
    v_add_u32 v5, s54, v4
    buffer_load_dwordx4 v[112:115], v5, s[28:31], s44 offen sc1
    buffer_load_dwordx4 v[116:119], v5, s[28:31], s45 offen sc1
    buffer_load_dwordx4 v[120:123], v5, s[28:31], s46 offen sc1
    buffer_load_dwordx4 v[124:127], v5, s[28:31], s47 offen sc1
    v_and_b32 v211, 1, v3
    v_lshlrev_b32 v211, 6, v211
    v_and_b32 v212, 2, v3
    v_lshl_add_u32 v204, v212, 4, v211
    v_bfe_u32 v211, v2, 1, 2
    v_lshlrev_b32 v211, 4, v211
    v_lshl_add_u32 v211, v2, 7, v211
    v_xor_b32 v209, v211, v204
    v_xor_b32 v210, 16, v209
    v_and_b32 v212, 1, v3
    v_lshl_add_u32 v211, v212, 6, v211
    v_lshrrev_b32 v212, 1, v3
    v_lshl_add_u32 v205, v212, 13, v211
    v_xor_b32 v206, 16, v205
    v_xor_b32 v207, 32, v205
    v_xor_b32 v208, 48, v205
    v_add_u32 v205, s66, v205
    v_add_u32 v206, s66, v206
    v_add_u32 v207, s66, v207
    v_add_u32 v208, s66, v208
    v_add_u32 v209, s66, v209
    v_add_u32 v210, s66, v210
    ds_read_b128 v[160:163], v205 offset:0
    ds_read_b128 v[164:167], v8 offset:57344
    ds_read_b128 v[168:171], v206 offset:0
    ds_read_b128 v[172:175], v8 offset:57360
    ds_read_b128 v[176:179], v207 offset:0
    ds_read_b128 v[180:183], v8 offset:57376
    ds_read_b128 v[184:187], v208 offset:0
    ds_read_b128 v[188:191], v8 offset:57392
    s_waitcnt lgkmcnt(0)
    v_mfma_f32_16x16x32_bf16 v[224:227], v[160:163], v[164:167], 0
    v_mfma_f32_16x16x32_bf16 v[224:227], v[168:171], v[172:175], v[224:227]
    v_mfma_f32_16x16x32_bf16 v[224:227], v[176:179], v[180:183], v[224:227]
    v_mfma_f32_16x16x32_bf16 v[224:227], v[184:187], v[188:191], v[224:227]
    ds_read_b128 v[160:163], v205 offset:16384
    ds_read_b128 v[164:167], v8 offset:57600
    ds_read_b128 v[168:171], v206 offset:16384
    ds_read_b128 v[172:175], v8 offset:57616
    ds_read_b128 v[176:179], v207 offset:16384
    ds_read_b128 v[180:183], v8 offset:57632
    ds_read_b128 v[184:187], v208 offset:16384
    ds_read_b128 v[188:191], v8 offset:57648
    s_waitcnt lgkmcnt(0)
    v_mfma_f32_16x16x32_bf16 v[224:227], v[160:163], v[164:167], v[224:227]
    v_mfma_f32_16x16x32_bf16 v[224:227], v[168:171], v[172:175], v[224:227]
    v_mfma_f32_16x16x32_bf16 v[224:227], v[176:179], v[180:183], v[224:227]
    v_mfma_f32_16x16x32_bf16 v[224:227], v[184:187], v[188:191], v[224:227]
    ds_read_b128 v[160:163], v205 offset:32768
    ds_read_b128 v[164:167], v8 offset:57856
    ds_read_b128 v[168:171], v206 offset:32768
    ds_read_b128 v[172:175], v8 offset:57872
    ds_read_b128 v[176:179], v207 offset:32768
    ds_read_b128 v[180:183], v8 offset:57888
    ds_read_b128 v[184:187], v208 offset:32768
    ds_read_b128 v[188:191], v8 offset:57904
    s_waitcnt lgkmcnt(0)
    v_mfma_f32_16x16x32_bf16 v[224:227], v[160:163], v[164:167], v[224:227]
    v_mfma_f32_16x16x32_bf16 v[224:227], v[168:171], v[172:175], v[224:227]
    v_mfma_f32_16x16x32_bf16 v[224:227], v[176:179], v[180:183], v[224:227]
    v_mfma_f32_16x16x32_bf16 v[224:227], v[184:187], v[188:191], v[224:227]
    ds_read_b128 v[160:163], v209 offset:49152
    ds_read_b128 v[164:167], v204 offset:58112
    ds_read_b128 v[168:171], v210 offset:49152
    ds_read_b128 v[172:175], v204 offset:58128
    s_waitcnt lgkmcnt(0)
    v_mfma_f32_16x16x32_bf16 v[224:227], v[160:163], v[164:167], v[224:227]
    v_mfma_f32_16x16x32_bf16 v[224:227], v[168:171], v[172:175], v[224:227]
    s_nop 7
    v_cvt_pk_bf16_f32 v224, v224, v225
    v_and_b32 v225, 0xffff0000, v224
    v_lshlrev_b32 v224, 16, v224
    v_cvt_pk_bf16_f32 v226, v226, v227
    v_and_b32 v227, 0xffff0000, v226
    v_lshlrev_b32 v226, 16, v226
    v_mul_f32 v224, 0xbfb8aa3b, v224
    v_mul_f32 v225, 0xbfb8aa3b, v225
    v_mul_f32 v226, 0xbfb8aa3b, v226
    v_mul_f32 v227, 0xbfb8aa3b, v227
    v_exp_f32 v224, v224
    v_exp_f32 v225, v225
    v_exp_f32 v226, v226
    v_exp_f32 v227, v227
    v_add_f32 v224, 1.0, v224
    v_add_f32 v225, 1.0, v225
    v_add_f32 v226, 1.0, v226
    v_add_f32 v227, 1.0, v227
    v_rcp_f32 v224, v224
    v_rcp_f32 v225, v225
    v_rcp_f32 v226, v226
    v_rcp_f32 v227, v227
    v_cvt_pk_bf16_f32 v224, v224, v225
    v_and_b32 v225, 0xffff0000, v224
    v_lshlrev_b32 v224, 16, v224
    v_cvt_pk_bf16_f32 v226, v226, v227
    v_and_b32 v227, 0xffff0000, v226
    v_lshlrev_b32 v226, 16, v226
    s_lshl_b32 s6, s3, 4
    v_add_u32 v211, s6, v8
    ds_write_b128 v211, v[224:227] offset:58368
    s_mul_i32 s6, s3, 2304
    v_mul_u32_u24 v211, 144, v2
    v_lshl_add_u32 v211, v3, 5, v211
    v_add_u32 v211, s6, v211
    v_lshrrev_b32 v212, 3, v1
    v_lshl_add_u32 v212, v212, 4, v9
    v_add_u32 v212, s6, v212
    ds_read_b128 v[144:147], v211 offset:59392
    ds_read_b128 v[148:151], v211 offset:59408
    s_waitcnt lgkmcnt(0)
    v_lshlrev_b32 v128, 16, v144
    v_and_b32 v129, 0xffff0000, v144
    v_lshlrev_b32 v130, 16, v145
    v_and_b32 v131, 0xffff0000, v145
    v_lshlrev_b32 v132, 16, v146
    v_and_b32 v133, 0xffff0000, v146
    v_lshlrev_b32 v134, 16, v147
    v_and_b32 v135, 0xffff0000, v147
    v_lshlrev_b32 v136, 16, v148
    v_and_b32 v137, 0xffff0000, v148
    v_lshlrev_b32 v138, 16, v149
    v_and_b32 v139, 0xffff0000, v149
    v_lshlrev_b32 v140, 16, v150
    v_and_b32 v141, 0xffff0000, v150
    v_lshlrev_b32 v142, 16, v151
    v_and_b32 v143, 0xffff0000, v151
    v_mul_f32 v128, v14, v128
    v_mul_f32 v129, v14, v129
    v_mul_f32 v130, v14, v130
    v_mul_f32 v131, v14, v131
    v_mul_f32 v132, v14, v132
    v_mul_f32 v133, v14, v133
    v_mul_f32 v134, v14, v134
    v_mul_f32 v135, v14, v135
    v_mul_f32 v136, v14, v136
    v_mul_f32 v137, v14, v137
    v_mul_f32 v138, v14, v138
    v_mul_f32 v139, v14, v139
    v_mul_f32 v140, v14, v140
    v_mul_f32 v141, v14, v141
    v_mul_f32 v142, v14, v142
    v_mul_f32 v143, v14, v143
    s_barrier
    s_mov_b32 s61, 0
PL3:
    buffer_load_dword v6, v10, s[28:31], 0 offen sc1
    s_waitcnt vmcnt(0)
PC3:
    v_cmp_ne_u32 vcc, s60, v6
    s_nop 4
    s_cbranch_vccz PD3
    s_add_u32 s61, s61, 1
    s_cmp_lt_u32 s61, 100000
    s_cbranch_scc1 PL3
PD3:
    v_add_u32 v5, s48, v4
    buffer_load_dwordx4 v[192:195], v5, s[28:31], s68 offen sc1
    buffer_load_dwordx4 v[196:199], v5, s[28:31], s69 offen sc1
    buffer_load_dwordx4 v[200:203], v5, s[28:31], s70 offen sc1
    buffer_load_dwordx4 v[204:207], v5, s[28:31], s71 offen sc1
    v_add_u32 v5, s49, v4
    buffer_load_dwordx4 v[208:211], v5, s[28:31], s68 offen sc1
    buffer_load_dwordx4 v[212:215], v5, s[28:31], s69 offen sc1
    buffer_load_dwordx4 v[216:219], v5, s[28:31], s70 offen sc1
    buffer_load_dwordx4 v[220:223], v5, s[28:31], s71 offen sc1
    v_add_u32 v5, s50, v4
    buffer_load_dwordx4 v[224:227], v5, s[28:31], s68 offen sc1
    buffer_load_dwordx4 v[228:231], v5, s[28:31], s69 offen sc1
    buffer_load_dwordx4 v[232:235], v5, s[28:31], s70 offen sc1
    buffer_load_dwordx4 v[236:239], v5, s[28:31], s71 offen sc1
    v_add_u32 v5, s51, v4
    buffer_load_dwordx4 v[240:243], v5, s[28:31], s68 offen sc1
    buffer_load_dwordx4 v[244:247], v5, s[28:31], s69 offen sc1
    buffer_load_dwordx4 v[248:251], v5, s[28:31], s70 offen sc1
    buffer_load_dwordx4 v[252:255], v5, s[28:31], s71 offen sc1
    buffer_load_dword v6, v12, s[28:31], 0 offen sc1
    s_mov_b32 s7, 32768
    s_waitcnt vmcnt(13)
    v_mfma_f32_16x16x32_bf16 v[144:147], v[192:195], v[20:23], 0
    v_mfma_f32_16x16x32_bf16 v[148:151], v[196:199], v[20:23], 0
    v_mfma_f32_16x16x32_bf16 v[152:155], v[200:203], v[20:23], 0
    v_mfma_f32_16x16x32_bf16 v[156:159], v[204:207], v[20:23], 0
    v_mfma_f32_16x16x32_bf16 v[160:163], v[192:195], v[24:27], 0
    v_mfma_f32_16x16x32_bf16 v[164:167], v[196:199], v[24:27], 0
    v_mfma_f32_16x16x32_bf16 v[168:171], v[200:203], v[24:27], 0
    v_mfma_f32_16x16x32_bf16 v[172:175], v[204:207], v[24:27], 0
    v_mfma_f32_16x16x32_bf16 v[176:179], v[192:195], v[28:31], 0
    v_mfma_f32_16x16x32_bf16 v[180:183], v[196:199], v[28:31], 0
    v_mfma_f32_16x16x32_bf16 v[184:187], v[200:203], v[28:31], 0
    v_mfma_f32_16x16x32_bf16 v[188:191], v[204:207], v[28:31], 0
    v_mfma_f32_16x16x32_bf16 v[128:131], v[192:195], v[16:19], v[128:131]
    v_mfma_f32_16x16x32_bf16 v[132:135], v[196:199], v[16:19], v[132:135]
    v_mfma_f32_16x16x32_bf16 v[136:139], v[200:203], v[16:19], v[136:139]
    v_mfma_f32_16x16x32_bf16 v[140:143], v[204:207], v[16:19], v[140:143]
    v_add_u32 v5, s52, v4
    buffer_load_dwordx4 v[192:195], v5, s[28:31], s68 offen sc1
    buffer_load_dwordx4 v[196:199], v5, s[28:31], s69 offen sc1
    buffer_load_dwordx4 v[200:203], v5, s[28:31], s70 offen sc1
    buffer_load_dwordx4 v[204:207], v5, s[28:31], s71 offen sc1
    s_waitcnt vmcnt(13)
    v_mfma_f32_16x16x32_bf16 v[144:147], v[208:211], v[36:39], v[144:147]
    v_mfma_f32_16x16x32_bf16 v[148:151], v[212:215], v[36:39], v[148:151]
    v_mfma_f32_16x16x32_bf16 v[152:155], v[216:219], v[36:39], v[152:155]
    v_mfma_f32_16x16x32_bf16 v[156:159], v[220:223], v[36:39], v[156:159]
    v_mfma_f32_16x16x32_bf16 v[160:163], v[208:211], v[40:43], v[160:163]
    v_mfma_f32_16x16x32_bf16 v[164:167], v[212:215], v[40:43], v[164:167]
    v_mfma_f32_16x16x32_bf16 v[168:171], v[216:219], v[40:43], v[168:171]
    v_mfma_f32_16x16x32_bf16 v[172:175], v[220:223], v[40:43], v[172:175]
    v_mfma_f32_16x16x32_bf16 v[176:179], v[208:211], v[44:47], v[176:179]
    v_mfma_f32_16x16x32_bf16 v[180:183], v[212:215], v[44:47], v[180:183]
    v_mfma_f32_16x16x32_bf16 v[184:187], v[216:219], v[44:47], v[184:187]
    v_mfma_f32_16x16x32_bf16 v[188:191], v[220:223], v[44:47], v[188:191]
    v_mfma_f32_16x16x32_bf16 v[128:131], v[208:211], v[32:35], v[128:131]
    v_mfma_f32_16x16x32_bf16 v[132:135], v[212:215], v[32:35], v[132:135]
    v_mfma_f32_16x16x32_bf16 v[136:139], v[216:219], v[32:35], v[136:139]
    v_mfma_f32_16x16x32_bf16 v[140:143], v[220:223], v[32:35], v[140:143]
    v_add_u32 v5, s53, v4
    buffer_load_dwordx4 v[208:211], v5, s[28:31], s68 offen sc1
    buffer_load_dwordx4 v[212:215], v5, s[28:31], s69 offen sc1
    buffer_load_dwordx4 v[216:219], v5, s[28:31], s70 offen sc1
    buffer_load_dwordx4 v[220:223], v5, s[28:31], s71 offen sc1
    s_waitcnt vmcnt(13)
    v_mfma_f32_16x16x32_bf16 v[144:147], v[224:227], v[52:55], v[144:147]
    v_mfma_f32_16x16x32_bf16 v[148:151], v[228:231], v[52:55], v[148:151]
    v_mfma_f32_16x16x32_bf16 v[152:155], v[232:235], v[52:55], v[152:155]
    v_mfma_f32_16x16x32_bf16 v[156:159], v[236:239], v[52:55], v[156:159]
    v_mfma_f32_16x16x32_bf16 v[160:163], v[224:227], v[56:59], v[160:163]
    v_mfma_f32_16x16x32_bf16 v[164:167], v[228:231], v[56:59], v[164:167]
    v_mfma_f32_16x16x32_bf16 v[168:171], v[232:235], v[56:59], v[168:171]
    v_mfma_f32_16x16x32_bf16 v[172:175], v[236:239], v[56:59], v[172:175]
    v_mfma_f32_16x16x32_bf16 v[176:179], v[224:227], v[60:63], v[176:179]
    v_mfma_f32_16x16x32_bf16 v[180:183], v[228:231], v[60:63], v[180:183]
    v_mfma_f32_16x16x32_bf16 v[184:187], v[232:235], v[60:63], v[184:187]
    v_mfma_f32_16x16x32_bf16 v[188:191], v[236:239], v[60:63], v[188:191]
    v_mfma_f32_16x16x32_bf16 v[128:131], v[224:227], v[48:51], v[128:131]
    v_mfma_f32_16x16x32_bf16 v[132:135], v[228:231], v[48:51], v[132:135]
    v_mfma_f32_16x16x32_bf16 v[136:139], v[232:235], v[48:51], v[136:139]
    v_mfma_f32_16x16x32_bf16 v[140:143], v[236:239], v[48:51], v[140:143]
    v_add_u32 v5, s54, v4
    buffer_load_dwordx4 v[224:227], v5, s[28:31], s68 offen sc1
    buffer_load_dwordx4 v[228:231], v5, s[28:31], s69 offen sc1
    buffer_load_dwordx4 v[232:235], v5, s[28:31], s70 offen sc1
    buffer_load_dwordx4 v[236:239], v5, s[28:31], s71 offen sc1
    s_waitcnt vmcnt(12)
    v_mfma_f32_16x16x32_bf16 v[144:147], v[240:243], v[68:71], v[144:147]
    v_mfma_f32_16x16x32_bf16 v[148:151], v[244:247], v[68:71], v[148:151]
    v_mfma_f32_16x16x32_bf16 v[152:155], v[248:251], v[68:71], v[152:155]
    v_mfma_f32_16x16x32_bf16 v[156:159], v[252:255], v[68:71], v[156:159]
    v_mfma_f32_16x16x32_bf16 v[160:163], v[240:243], v[72:75], v[160:163]
    v_mfma_f32_16x16x32_bf16 v[164:167], v[244:247], v[72:75], v[164:167]
    v_mfma_f32_16x16x32_bf16 v[168:171], v[248:251], v[72:75], v[168:171]
    v_mfma_f32_16x16x32_bf16 v[172:175], v[252:255], v[72:75], v[172:175]
    v_mfma_f32_16x16x32_bf16 v[176:179], v[240:243], v[76:79], v[176:179]
    v_mfma_f32_16x16x32_bf16 v[180:183], v[244:247], v[76:79], v[180:183]
    v_mfma_f32_16x16x32_bf16 v[184:187], v[248:251], v[76:79], v[184:187]
    v_mfma_f32_16x16x32_bf16 v[188:191], v[252:255], v[76:79], v[188:191]
    v_mfma_f32_16x16x32_bf16 v[128:131], v[240:243], v[64:67], v[128:131]
    v_mfma_f32_16x16x32_bf16 v[132:135], v[244:247], v[64:67], v[132:135]
    v_mfma_f32_16x16x32_bf16 v[136:139], v[248:251], v[64:67], v[136:139]
    v_mfma_f32_16x16x32_bf16 v[140:143], v[252:255], v[64:67], v[140:143]
    s_waitcnt vmcnt(8)
    v_mfma_f32_16x16x32_bf16 v[144:147], v[192:195], v[84:87], v[144:147]
    v_mfma_f32_16x16x32_bf16 v[148:151], v[196:199], v[84:87], v[148:151]
    v_mfma_f32_16x16x32_bf16 v[152:155], v[200:203], v[84:87], v[152:155]
    v_mfma_f32_16x16x32_bf16 v[156:159], v[204:207], v[84:87], v[156:159]
    v_mfma_f32_16x16x32_bf16 v[160:163], v[192:195], v[88:91], v[160:163]
    v_mfma_f32_16x16x32_bf16 v[164:167], v[196:199], v[88:91], v[164:167]
    v_mfma_f32_16x16x32_bf16 v[168:171], v[200:203], v[88:91], v[168:171]
    v_mfma_f32_16x16x32_bf16 v[172:175], v[204:207], v[88:91], v[172:175]
    v_mfma_f32_16x16x32_bf16 v[176:179], v[192:195], v[92:95], v[176:179]
    v_mfma_f32_16x16x32_bf16 v[180:183], v[196:199], v[92:95], v[180:183]
    v_mfma_f32_16x16x32_bf16 v[184:187], v[200:203], v[92:95], v[184:187]
    v_mfma_f32_16x16x32_bf16 v[188:191], v[204:207], v[92:95], v[188:191]
    v_mfma_f32_16x16x32_bf16 v[128:131], v[192:195], v[80:83], v[128:131]
    v_mfma_f32_16x16x32_bf16 v[132:135], v[196:199], v[80:83], v[132:135]
    v_mfma_f32_16x16x32_bf16 v[136:139], v[200:203], v[80:83], v[136:139]
    v_mfma_f32_16x16x32_bf16 v[140:143], v[204:207], v[80:83], v[140:143]
    v_cmp_ne_u32 vcc, s60, v6
    s_nop 0
    s_mov_b64 s[62:63], vcc
    s_nop 2
    s_cbranch_vccz B_A1
    buffer_load_dword v6, v12, s[28:31], 0 offen sc1
    buffer_load_dword v6, v12, s[28:31], 0 offen sc1
    s_branch B_A2
B_A1:
    buffer_load_dwordx4 v[240:243], v11, s[28:31], 0 offen sc1
    buffer_load_dwordx4 v[244:247], v11, s[28:31], s7 offen sc1
B_A2:
    s_waitcnt vmcnt(6)
    v_mfma_f32_16x16x32_bf16 v[144:147], v[208:211], v[100:103], v[144:147]
    v_mfma_f32_16x16x32_bf16 v[148:151], v[212:215], v[100:103], v[148:151]
    v_mfma_f32_16x16x32_bf16 v[152:155], v[216:219], v[100:103], v[152:155]
    v_mfma_f32_16x16x32_bf16 v[156:159], v[220:223], v[100:103], v[156:159]
    v_mfma_f32_16x16x32_bf16 v[160:163], v[208:211], v[104:107], v[160:163]
    v_mfma_f32_16x16x32_bf16 v[164:167], v[212:215], v[104:107], v[164:167]
    v_mfma_f32_16x16x32_bf16 v[168:171], v[216:219], v[104:107], v[168:171]
    v_mfma_f32_16x16x32_bf16 v[172:175], v[220:223], v[104:107], v[172:175]
    v_mfma_f32_16x16x32_bf16 v[176:179], v[208:211], v[108:111], v[176:179]
    v_mfma_f32_16x16x32_bf16 v[180:183], v[212:215], v[108:111], v[180:183]
    v_mfma_f32_16x16x32_bf16 v[184:187], v[216:219], v[108:111], v[184:187]
    v_mfma_f32_16x16x32_bf16 v[188:191], v[220:223], v[108:111], v[188:191]
    v_mfma_f32_16x16x32_bf16 v[128:131], v[208:211], v[96:99], v[128:131]
    v_mfma_f32_16x16x32_bf16 v[132:135], v[212:215], v[96:99], v[132:135]
    v_mfma_f32_16x16x32_bf16 v[136:139], v[216:219], v[96:99], v[136:139]
    v_mfma_f32_16x16x32_bf16 v[140:143], v[220:223], v[96:99], v[140:143]
    s_waitcnt vmcnt(2)
    v_mfma_f32_16x16x32_bf16 v[144:147], v[224:227], v[116:119], v[144:147]
    v_mfma_f32_16x16x32_bf16 v[148:151], v[228:231], v[116:119], v[148:151]
    v_mfma_f32_16x16x32_bf16 v[152:155], v[232:235], v[116:119], v[152:155]
    v_mfma_f32_16x16x32_bf16 v[156:159], v[236:239], v[116:119], v[156:159]
    v_mfma_f32_16x16x32_bf16 v[160:163], v[224:227], v[120:123], v[160:163]
    v_mfma_f32_16x16x32_bf16 v[164:167], v[228:231], v[120:123], v[164:167]
    v_mfma_f32_16x16x32_bf16 v[168:171], v[232:235], v[120:123], v[168:171]
    v_mfma_f32_16x16x32_bf16 v[172:175], v[236:239], v[120:123], v[172:175]
    v_mfma_f32_16x16x32_bf16 v[176:179], v[224:227], v[124:127], v[176:179]
    v_mfma_f32_16x16x32_bf16 v[180:183], v[228:231], v[124:127], v[180:183]
    v_mfma_f32_16x16x32_bf16 v[184:187], v[232:235], v[124:127], v[184:187]
    v_mfma_f32_16x16x32_bf16 v[188:191], v[236:239], v[124:127], v[188:191]
    v_mfma_f32_16x16x32_bf16 v[128:131], v[224:227], v[112:115], v[128:131]
    v_mfma_f32_16x16x32_bf16 v[132:135], v[228:231], v[112:115], v[132:135]
    v_mfma_f32_16x16x32_bf16 v[136:139], v[232:235], v[112:115], v[136:139]
    v_mfma_f32_16x16x32_bf16 v[140:143], v[236:239], v[112:115], v[140:143]
    ds_write_b128 v13, v[144:147] offset:0
    ds_write_b128 v13, v[148:151] offset:1024
    ds_write_b128 v13, v[152:155] offset:8192
    ds_write_b128 v13, v[156:159] offset:9216
    ds_write_b128 v13, v[160:163] offset:16384
    ds_write_b128 v13, v[164:167] offset:17408
    ds_write_b128 v13, v[168:171] offset:24576
    ds_write_b128 v13, v[172:175] offset:25600
    ds_write_b128 v13, v[176:179] offset:32768
    ds_write_b128 v13, v[180:183] offset:33792
    ds_write_b128 v13, v[184:187] offset:40960
    ds_write_b128 v13, v[188:191] offset:41984
    ds_read_b128 v[32:35], v8 offset:58368
    ds_read_b128 v[36:39], v8 offset:58384
    ds_read_b128 v[40:43], v8 offset:58400
    ds_read_b128 v[44:47], v8 offset:58416
    s_cmp_eq_u64 s[62:63], 0
    s_cbranch_scc1 B_A3
    s_waitcnt vmcnt(0)
    s_mov_b32 s61, 0
    s_branch PC4
PL4:
    buffer_load_dword v6, v12, s[28:31], 0 offen sc1
    s_waitcnt vmcnt(0)
PC4:
    v_cmp_ne_u32 vcc, s60, v6
    s_nop 4
    s_cbranch_vccz PD4
    s_add_u32 s61, s61, 1
    s_cmp_lt_u32 s61, 100000
    s_cbranch_scc1 PL4
PD4:
    buffer_load_dwordx4 v[240:243], v11, s[28:31], 0 offen sc1
    buffer_load_dwordx4 v[244:247], v11, s[28:31], s7 offen sc1
B_A3:
    s_mul_i32 s6, s3, 2304
    v_mul_u32_u24 v5, 144, v2
    v_lshl_add_u32 v5, v3, 5, v5
    v_add_u32 v5, s6, v5
    v_lshrrev_b32 v6, 3, v1
    v_lshl_add_u32 v6, v6, 4, v9
    v_add_u32 v6, s6, v6
    s_lshl_b32 s6, s4, 6
    v_lshl_add_u32 v12, v3, 4, s6
    v_mul_u32_u24 v12, 1792, v12
    v_lshl_add_u32 v12, v7, 1, v12
    s_waitcnt lgkmcnt(0)
    s_barrier
    s_sub_u32 s6, s3, 1
    s_and_b32 s6, s6, 3
    s_lshl_b32 s6, s6, 11
    v_add_u32 v10, s6, v9
    ds_read_b128 v[144:147], v10 offset:0
    ds_read_b128 v[148:151], v10 offset:1024
    ds_read_b128 v[152:155], v10 offset:8192
    ds_read_b128 v[156:159], v10 offset:9216
    s_sub_u32 s6, s3, 2
    s_and_b32 s6, s6, 3
    s_lshl_b32 s6, s6, 11
    v_add_u32 v10, s6, v9
    ds_read_b128 v[160:163], v10 offset:16384
    ds_read_b128 v[164:167], v10 offset:17408
    ds_read_b128 v[168:171], v10 offset:24576
    ds_read_b128 v[172:175], v10 offset:25600
    s_sub_u32 s6, s3, 3
    s_and_b32 s6, s6, 3
    s_lshl_b32 s6, s6, 11
    v_add_u32 v10, s6, v9
    ds_read_b128 v[176:179], v10 offset:32768
    ds_read_b128 v[180:183], v10 offset:33792
    ds_read_b128 v[184:187], v10 offset:40960
    ds_read_b128 v[188:191], v10 offset:41984
    v_sub_f32 v48, 1.0, v32
    v_sub_f32 v49, 1.0, v33
    v_cvt_pk_bf16_f32 v48, v48, v49
    v_and_b32 v49, 0xffff0000, v48
    v_lshlrev_b32 v48, 16, v48
    v_sub_f32 v50, 1.0, v34
    v_sub_f32 v51, 1.0, v35
    v_cvt_pk_bf16_f32 v50, v50, v51
    v_and_b32 v51, 0xffff0000, v50
    v_lshlrev_b32 v50, 16, v50
    v_sub_f32 v52, 1.0, v36
    v_sub_f32 v53, 1.0, v37
    v_cvt_pk_bf16_f32 v52, v52, v53
    v_and_b32 v53, 0xffff0000, v52
    v_lshlrev_b32 v52, 16, v52
    v_sub_f32 v54, 1.0, v38
    v_sub_f32 v55, 1.0, v39
    v_cvt_pk_bf16_f32 v54, v54, v55
    v_and_b32 v55, 0xffff0000, v54
    v_lshlrev_b32 v54, 16, v54
    v_sub_f32 v56, 1.0, v40
    v_sub_f32 v57, 1.0, v41
    v_cvt_pk_bf16_f32 v56, v56, v57
    v_and_b32 v57, 0xffff0000, v56
    v_lshlrev_b32 v56, 16, v56
    v_sub_f32 v58, 1.0, v42
    v_sub_f32 v59, 1.0, v43
    v_cvt_pk_bf16_f32 v58, v58, v59
    v_and_b32 v59, 0xffff0000, v58
    v_lshlrev_b32 v58, 16, v58
    v_sub_f32 v60, 1.0, v44
    v_sub_f32 v61, 1.0, v45
    v_cvt_pk_bf16_f32 v60, v60, v61
    v_and_b32 v61, 0xffff0000, v60
    v_lshlrev_b32 v60, 16, v60
    v_sub_f32 v62, 1.0, v46
    v_sub_f32 v63, 1.0, v47
    v_cvt_pk_bf16_f32 v62, v62, v63
    v_and_b32 v63, 0xffff0000, v62
    v_lshlrev_b32 v62, 16, v62
    s_waitcnt vmcnt(0)
    ds_write_b128 v6, v[240:243] offset:59392
    ds_write_b128 v6, v[244:247] offset:60544
    ds_read_b128 v[240:243], v5 offset:59392
    ds_read_b128 v[244:247], v5 offset:59408
    s_waitcnt lgkmcnt(12)
    v_pk_add_f32 v[128:129], v[128:129], v[144:145]
    v_pk_add_f32 v[130:131], v[130:131], v[146:147]
    v_pk_add_f32 v[132:133], v[132:133], v[148:149]
    v_pk_add_f32 v[134:135], v[134:135], v[150:151]
    v_pk_add_f32 v[136:137], v[136:137], v[152:153]
    v_pk_add_f32 v[138:139], v[138:139], v[154:155]
    v_pk_add_f32 v[140:141], v[140:141], v[156:157]
    v_pk_add_f32 v[142:143], v[142:143], v[158:159]
    s_waitcnt lgkmcnt(8)
    v_pk_add_f32 v[128:129], v[128:129], v[160:161]
    v_pk_add_f32 v[130:131], v[130:131], v[162:163]
    v_pk_add_f32 v[132:133], v[132:133], v[164:165]
    v_pk_add_f32 v[134:135], v[134:135], v[166:167]
    v_pk_add_f32 v[136:137], v[136:137], v[168:169]
    v_pk_add_f32 v[138:139], v[138:139], v[170:171]
    v_pk_add_f32 v[140:141], v[140:141], v[172:173]
    v_pk_add_f32 v[142:143], v[142:143], v[174:175]
    s_waitcnt lgkmcnt(4)
    v_pk_add_f32 v[128:129], v[128:129], v[176:177]
    v_pk_add_f32 v[130:131], v[130:131], v[178:179]
    v_pk_add_f32 v[132:133], v[132:133], v[180:181]
    v_pk_add_f32 v[134:135], v[134:135], v[182:183]
    v_pk_add_f32 v[136:137], v[136:137], v[184:185]
    v_pk_add_f32 v[138:139], v[138:139], v[186:187]
    v_pk_add_f32 v[140:141], v[140:141], v[188:189]
    v_pk_add_f32 v[142:143], v[142:143], v[190:191]
    s_waitcnt lgkmcnt(0)
    v_lshlrev_b32 v64, 16, v240
    v_and_b32 v65, 0xffff0000, v240
    v_lshlrev_b32 v66, 16, v241
    v_and_b32 v67, 0xffff0000, v241
    v_lshlrev_b32 v68, 16, v242
    v_and_b32 v69, 0xffff0000, v242
    v_lshlrev_b32 v70, 16, v243
    v_and_b32 v71, 0xffff0000, v243
    v_lshlrev_b32 v72, 16, v244
    v_and_b32 v73, 0xffff0000, v244
    v_lshlrev_b32 v74, 16, v245
    v_and_b32 v75, 0xffff0000, v245
    v_lshlrev_b32 v76, 16, v246
    v_and_b32 v77, 0xffff0000, v246
    v_lshlrev_b32 v78, 16, v247
    v_and_b32 v79, 0xffff0000, v247
    v_pk_mul_f32 v[64:65], v[64:65], v[32:33]
    v_pk_mul_f32 v[66:67], v[66:67], v[34:35]
    v_pk_mul_f32 v[68:69], v[68:69], v[36:37]
    v_pk_mul_f32 v[70:71], v[70:71], v[38:39]
    v_pk_mul_f32 v[72:73], v[72:73], v[40:41]
    v_pk_mul_f32 v[74:75], v[74:75], v[42:43]
    v_pk_mul_f32 v[76:77], v[76:77], v[44:45]
    v_pk_mul_f32 v[78:79], v[78:79], v[46:47]
    v_pk_fma_f32 v[128:129], v[128:129], v[48:49], v[64:65]
    s_mov_b32 s6, 0
    buffer_store_dword v128, v12, s[32:35], s6 offen offset:0 sc0 sc1
    buffer_store_dword v129, v12, s[32:35], s6 offen offset:1792 sc0 sc1
    v_pk_fma_f32 v[130:131], v[130:131], v[50:51], v[66:67]
    s_mov_b32 s6, 3584
    buffer_store_dword v130, v12, s[32:35], s6 offen offset:0 sc0 sc1
    buffer_store_dword v131, v12, s[32:35], s6 offen offset:1792 sc0 sc1
    v_pk_fma_f32 v[132:133], v[132:133], v[52:53], v[68:69]
    s_mov_b32 s6, 7168
    buffer_store_dword v132, v12, s[32:35], s6 offen offset:0 sc0 sc1
    buffer_store_dword v133, v12, s[32:35], s6 offen offset:1792 sc0 sc1
    v_pk_fma_f32 v[134:135], v[134:135], v[54:55], v[70:71]
    s_mov_b32 s6, 10752
    buffer_store_dword v134, v12, s[32:35], s6 offen offset:0 sc0 sc1
    buffer_store_dword v135, v12, s[32:35], s6 offen offset:1792 sc0 sc1
    v_pk_fma_f32 v[136:137], v[136:137], v[56:57], v[72:73]
    s_mov_b32 s6, 14336
    buffer_store_dword v136, v12, s[32:35], s6 offen offset:0 sc0 sc1
    buffer_store_dword v137, v12, s[32:35], s6 offen offset:1792 sc0 sc1
    v_pk_fma_f32 v[138:139], v[138:139], v[58:59], v[74:75]
    s_mov_b32 s6, 17920
    buffer_store_dword v138, v12, s[32:35], s6 offen offset:0 sc0 sc1
    buffer_store_dword v139, v12, s[32:35], s6 offen offset:1792 sc0 sc1
    v_pk_fma_f32 v[140:141], v[140:141], v[60:61], v[76:77]
    s_mov_b32 s6, 21504
    buffer_store_dword v140, v12, s[32:35], s6 offen offset:0 sc0 sc1
    buffer_store_dword v141, v12, s[32:35], s6 offen offset:1792 sc0 sc1
    v_pk_fma_f32 v[142:143], v[142:143], v[62:63], v[78:79]
    s_mov_b32 s6, 25088
    buffer_store_dword v142, v12, s[32:35], s6 offen offset:0 sc0 sc1
    buffer_store_dword v143, v12, s[32:35], s6 offen offset:1792 sc0 sc1
    s_endpgm
L_AROLE:
    s_load_dwordx2 s[8:9], s[0:1], 8
    s_mov_b32 s10, 229376
    s_mov_b32 s11, 0x20000
    s_load_dwordx2 s[12:13], s[0:1], 16
    s_mov_b32 s14, 229376
    s_mov_b32 s15, 0x20000
    s_load_dwordx2 s[16:17], s[0:1], 24
    s_mov_b32 s18, 229376
    s_mov_b32 s19, 0x20000
    s_load_dwordx2 s[20:21], s[0:1], 32
    s_mov_b32 s22, 229376
    s_mov_b32 s23, 0x20000
    s_load_dwordx2 s[24:25], s[0:1], 40
    s_mov_b32 s26, 229376
    s_mov_b32 s27, 0x20000
    s_load_dwordx2 s[28:29], s[0:1], 48
    s_mov_b32 s30, 229376
    s_mov_b32 s31, 0x20000
    s_load_dwordx2 s[32:33], s[0:1], 168
    s_mov_b32 s34, 33554432
    s_mov_b32 s35, 0x20000
    s_load_dwordx2 s[40:41], s[0:1], 160
    s_mov_b32 s42, 256
    s_mov_b32 s43, 0x20000
    s_load_dwordx2 s[56:57], s[0:1], 112
    s_mov_b32 s58, 401408
    s_mov_b32 s59, 0x20000
    s_load_dwordx2 s[64:65], s[0:1], 120
    s_mov_b32 s66, 401408
    s_mov_b32 s67, 0x20000
    s_and_b32 s49, s3, 1
    s_lshl_b32 s49, s49, 3
    s_add_u32 s49, s49, 96
    s_load_dwordx2 s[36:37], s[0:1], s49
    s_mov_b32 s38, 401408
    s_mov_b32 s39, 0x20000
    s_load_dwordx2 s[44:45], s[0:1], 56
    s_load_dwordx2 s[46:47], s[0:1], 64
    s_memrealtime s[68:69]
    s_mov_b32 s4, s2
    s_and_b32 s5, s4, 7
    s_mul_i32 s5, s5, 28
    s_lshr_b32 s4, s4, 3
    s_add_u32 s4, s4, s5
    s_lshr_b32 s5, s3, 1
    s_and_b32 s6, s3, 1
    s_lshl_b32 s7, s4, 1
    s_add_u32 s7, s7, s5
    s_lshl_b32 s48, s7, 9
    s_lshl_b32 s49, s6, 8
    s_add_u32 s48, s48, s49
    v_lshlrev_b32 v4, 2, v1
    s_lshl_b32 s50, s4, 2
    s_waitcnt lgkmcnt(0)
    s_setprio 3
    s_or_b32 s49, s2, s3
    s_cmp_lg_u32 s49, 0
    s_cbranch_scc1 A_NON
    s_or_b32 s68, s68, 0x80000000
    v_mov_b32 v10, s68
    buffer_store_dword v10, off, s[40:43], 0 sc1
A_NON:
    s_min_u32 s62, s4, 195
    s_mul_i32 s54, s62, 9363
    s_lshr_b32 s54, s54, 16
    s_mul_i32 s55, s54, 7
    s_sub_u32 s55, s62, s55
    v_lshrrev_b32 v176, 4, v0
    s_lshl_b32 s49, s55, 4
    v_add_u32 v176, s49, v176
    s_lshl_b32 s49, s54, 4
    v_add_u32 v177, s49, v2
    v_mul_u32_u24 v177, 896, v177
    v_lshl_add_u32 v177, v176, 3, v177
    buffer_load_dwordx2 v[178:179], v177, s[56:59], 0 offen
    buffer_load_dwordx2 v[180:181], v177, s[64:67], 0 offen
    buffer_load_dword v16, v4, s[8:11], s48 offen
    buffer_load_dword v17, v4, s[12:15], s48 offen
    buffer_load_dword v18, v4, s[16:19], s48 offen
    buffer_load_dword v19, v4, s[20:23], s48 offen
    buffer_load_dword v20, v4, s[24:27], s48 offen
    buffer_load_dword v21, v4, s[28:31], s48 offen
    v_lshlrev_b32 v176, 8, v176
    v_lshl_add_u32 v176, v2, 4, v176
    s_mul_i32 s54, s54, 28672
    s_add_u32 s54, s54, 2097152
    s_load_dword s51, s[44:45], s50
    s_load_dword s52, s[46:47], s50
    s_lshl_b32 s49, s7, 12
    s_add_u32 s36, s32, s49
    s_addc_u32 s37, s33, 0
    s_mov_b32 s38, 4096
    s_mov_b32 s39, 0x20000
    s_lshl_b32 s53, s5, 15
    v_mov_b32 v8, 0
    v_mov_b32 v9, 0
    v_mov_b32 v10, 0
    v_mov_b32 v11, 0
    v_and_b32 v5, 7, v1
    v_lshrrev_b32 v6, 1, v5
    v_mul_u32_u24 v6, 4160, v6
    v_and_b32 v5, 1, v5
    v_lshl_add_u32 v5, v5, 4, v6
    v_add_u32 v5, s53, v5
    ds_write_b128 v5, v[8:11]
    v_min_u32 v5, 31, v1
    v_lshlrev_b32 v5, 4, v5
    v_add_u32 v5, s53, v5
    ds_write_b128 v5, v[8:11] offset:20736
    v_subrev_u32 v12, 8, v2
    v_lshlrev_b32 v12, 9, v12
    v_min_u32 v12, 0x800, v12
    v_cmp_eq_u32 vcc, 8, v2
    v_mov_b32 v7, 516
    s_nop 0
    v_cndmask_b32 v12, v12, v7, vcc
    v_cmp_gt_u32 vcc, 8, v2
    s_nop 1
    v_cndmask_b32 v12, v12, v2, vcc
    v_cvt_f32_u32 v12, v12
    v_lshlrev_b32 v14, 3, v2
    v_cvt_f32_u32 v14, v14
    v_lshl_add_u32 v6, v3, 2, 0
    v_subrev_u32 v240, 8, v6
    v_lshlrev_b32 v240, 9, v240
    v_min_u32 v240, 0x800, v240
    v_cmp_eq_u32 vcc, 8, v6
    v_mov_b32 v7, 516
    s_nop 0
    v_cndmask_b32 v240, v240, v7, vcc
    v_cmp_gt_u32 vcc, 8, v6
    s_nop 1
    v_cndmask_b32 v240, v240, v6, vcc
    v_lshl_add_u32 v240, v2, 3, v240
    v_lshlrev_b32 v240, 1, v240
    s_lshl_b32 s49, s6, 9
    s_add_u32 s49, s49, s53
    v_add_u32 v240, s49, v240
    v_lshl_add_u32 v6, v3, 2, 1
    v_subrev_u32 v241, 8, v6
    v_lshlrev_b32 v241, 9, v241
    v_min_u32 v241, 0x800, v241
    v_cmp_eq_u32 vcc, 8, v6
    v_mov_b32 v7, 516
    s_nop 0
    v_cndmask_b32 v241, v241, v7, vcc
    v_cmp_gt_u32 vcc, 8, v6
    s_nop 1
    v_cndmask_b32 v241, v241, v6, vcc
    v_lshl_add_u32 v241, v2, 3, v241
    v_lshlrev_b32 v241, 1, v241
    s_lshl_b32 s49, s6, 9
    s_add_u32 s49, s49, s53
    v_add_u32 v241, s49, v241
    v_lshl_add_u32 v6, v3, 2, 2
    v_subrev_u32 v242, 8, v6
    v_lshlrev_b32 v242, 9, v242
    v_min_u32 v242, 0x800, v242
    v_cmp_eq_u32 vcc, 8, v6
    v_mov_b32 v7, 516
    s_nop 0
    v_cndmask_b32 v242, v242, v7, vcc
    v_cmp_gt_u32 vcc, 8, v6
    s_nop 1
    v_cndmask_b32 v242, v242, v6, vcc
    v_lshl_add_u32 v242, v2, 3, v242
    v_lshlrev_b32 v242, 1, v242
    s_lshl_b32 s49, s6, 9
    s_add_u32 s49, s49, s53
    v_add_u32 v242, s49, v242
    v_lshl_add_u32 v6, v3, 2, 3
    v_subrev_u32 v243, 8, v6
    v_lshlrev_b32 v243, 9, v243
    v_min_u32 v243, 0x800, v243
    v_cmp_eq_u32 vcc, 8, v6
    v_mov_b32 v7, 516
    s_nop 0
    v_cndmask_b32 v243, v243, v7, vcc
    v_cmp_gt_u32 vcc, 8, v6
    s_nop 1
    v_cndmask_b32 v243, v243, v6, vcc
    v_lshl_add_u32 v243, v2, 3, v243
    v_lshlrev_b32 v243, 1, v243
    s_lshl_b32 s49, s6, 9
    s_add_u32 s49, s49, s53
    v_add_u32 v243, s49, v243
    s_lshl_b32 s49, s6, 6
    v_add_u32 v15, s49, v1
    v_lshlrev_b32 v6, 1, v15
    v_sub_u32 v244, 1279, v6
    v_sub_u32 v245, 1278, v6
    v_cvt_f32_u32 v244, v244
    v_cvt_f32_u32 v245, v245
    v_cvt_pk_bf16_f32 v6, v244, v245
    v_lshlrev_b32 v244, 16, v6
    v_and_b32 v245, 0xffff0000, v6
    v_cvt_u32_f32 v244, v244
    v_lshl_add_u32 v244, v244, 1, s53
    v_cvt_u32_f32 v245, v245
    v_lshl_add_u32 v245, v245, 1, s53
    v_lshlrev_b32 v6, 1, v15
    v_sub_u32 v246, 767, v6
    v_sub_u32 v247, 766, v6
    v_cvt_f32_u32 v246, v246
    v_cvt_f32_u32 v247, v247
    v_cvt_pk_bf16_f32 v6, v246, v247
    v_lshlrev_b32 v246, 16, v6
    v_and_b32 v247, 0xffff0000, v6
    v_cvt_u32_f32 v246, v246
    v_lshl_add_u32 v246, v246, 1, s53
    v_cvt_u32_f32 v247, v247
    v_lshl_add_u32 v247, v247, 1, s53
    v_lshlrev_b32 v6, 1, v15
    v_sub_u32 v248, 511, v6
    v_sub_u32 v249, 510, v6
    v_cvt_f32_u32 v248, v248
    v_cvt_f32_u32 v249, v249
    v_cvt_pk_bf16_f32 v6, v248, v249
    v_lshlrev_b32 v248, 16, v6
    v_and_b32 v249, 0xffff0000, v6
    v_cvt_u32_f32 v248, v248
    v_lshl_add_u32 v248, v248, 1, s53
    v_cvt_u32_f32 v249, v249
    v_lshl_add_u32 v249, v249, 1, s53
    v_lshlrev_b32 v6, 1, v15
    v_sub_u32 v250, 255, v6
    v_sub_u32 v251, 254, v6
    v_cvt_f32_u32 v250, v250
    v_cvt_f32_u32 v251, v251
    v_cvt_pk_bf16_f32 v6, v250, v251
    v_lshlrev_b32 v250, 16, v6
    v_and_b32 v251, 0xffff0000, v6
    v_cvt_u32_f32 v250, v250
    v_lshl_add_u32 v250, v250, 1, s53
    v_cvt_u32_f32 v251, v251
    v_lshl_add_u32 v251, v251, 1, s53
    s_waitcnt vmcnt(6)
    s_mov_b32 s49, 0x05040100
    s_mov_b32 s55, 0x07060302
    v_perm_b32 v184, v180, v178, s49
    v_perm_b32 v185, v180, v178, s55
    v_perm_b32 v186, v181, v179, s49
    v_perm_b32 v187, v181, v179, s55
    buffer_store_dwordx4 v[184:187], v176, s[32:35], s54 offen sc1
    buffer_load_dword v252, off, s[40:43], 0 sc1
    s_waitcnt vmcnt(2) lgkmcnt(0)
    s_lshl_b32 s49, s5, 4
    s_lshr_b32 s51, s51, s49
    s_lshl_b32 s51, s51, 16
    s_lshr_b32 s52, s52, s49
    s_lshl_b32 s52, s52, 16
    v_mov_b32 v5, s51
    v_mul_f32 v5, 0x3fb8aa3b, v5
    v_exp_f32 v5, v5
    s_nop 0
    v_cvt_pk_bf16_f32 v5, v5, v5
    v_and_b32 v5, 0xffff0000, v5
    v_lshlrev_b32 v24, 16, v16
    v_lshlrev_b32 v25, 16, v17
    v_lshlrev_b32 v36, 16, v18
    v_lshlrev_b32 v37, 16, v19
    v_lshlrev_b32 v38, 16, v20
    v_lshlrev_b32 v39, 16, v21
    v_mul_f32 v24, v5, v24
    v_mul_f32 v25, v5, v25
    v_mul_f32 v36, v5, v36
    v_mul_f32 v37, v5, v37
    v_mul_f32 v24, 0x3fb8aa3b, v24
    v_mul_f32 v25, 0x3e22f983, v25
    v_pk_mul_f32 v[40:41], v[36:37], v[38:39] op_sel:[0,0] op_sel_hi:[0,1]
    v_pk_fma_f32 v[28:29], v[36:37], v[38:39], v[40:41] op_sel:[1,1,0] op_sel_hi:[1,0,1] neg_lo:[0,1,0]
    v_mul_f32 v42, 0x43000000, v24
    v_mul_f32 v43, 0x43000000, v25
    v_exp_f32 v42, v42
    v_fract_f32 v43, v43
    v_cos_f32 v32, v43
    v_sin_f32 v33, v43
    v_mul_f32 v32, v42, v32
    v_mul_f32 v33, v42, v33
    v_and_b32 v26, 0xffff0000, v16
    v_and_b32 v27, 0xffff0000, v17
    v_and_b32 v36, 0xffff0000, v18
    v_and_b32 v37, 0xffff0000, v19
    v_and_b32 v38, 0xffff0000, v20
    v_and_b32 v39, 0xffff0000, v21
    v_mul_f32 v26, v5, v26
    v_mul_f32 v27, v5, v27
    v_mul_f32 v36, v5, v36
    v_mul_f32 v37, v5, v37
    v_mul_f32 v26, 0x3fb8aa3b, v26
    v_mul_f32 v27, 0x3e22f983, v27
    v_pk_mul_f32 v[40:41], v[36:37], v[38:39] op_sel:[0,0] op_sel_hi:[0,1]
    v_pk_fma_f32 v[30:31], v[36:37], v[38:39], v[40:41] op_sel:[1,1,0] op_sel_hi:[1,0,1] neg_lo:[0,1,0]
    v_mul_f32 v42, 0x43000000, v26
    v_mul_f32 v43, 0x43000000, v27
    v_exp_f32 v42, v42
    v_fract_f32 v43, v43
    v_cos_f32 v34, v43
    v_sin_f32 v35, v43
    v_mul_f32 v34, v42, v34
    v_mul_f32 v35, v42, v35
    s_mul_i32 s49, s6, 3072
    s_add_u32 s49, s49, s53
    v_lshl_add_u32 v5, v1, 4, s49
    v_lshl_add_u32 v6, v3, 5, s49
    ds_write_b128 v5, v[24:27] offset:26368
    ds_write_b128 v5, v[28:31] offset:27392
    ds_write_b128 v5, v[32:35] offset:28416
    s_waitcnt lgkmcnt(0)
    ds_read_b128 v[16:19], v6 offset:26368
    ds_read_b128 v[20:23], v6 offset:26384
    ds_read_b128 v[24:27], v6 offset:27392
    ds_read_b128 v[28:31], v6 offset:27408
    ds_read_b128 v[32:35], v6 offset:28416
    ds_read_b128 v[36:39], v6 offset:28432
    ds_read_b128 v[40:43], v6 offset:26496
    ds_read_b128 v[44:47], v6 offset:26512
    ds_read_b128 v[48:51], v6 offset:27520
    ds_read_b128 v[52:55], v6 offset:27536
    ds_read_b128 v[56:59], v6 offset:28544
    ds_read_b128 v[60:63], v6 offset:28560
    s_waitcnt lgkmcnt(6)
    v_pk_mul_f32 v[64:65], v[16:17], v[12:13] op_sel_hi:[1,0]
    v_pk_mul_f32 v[66:67], v[18:19], v[12:13] op_sel_hi:[1,0]
    v_pk_mul_f32 v[68:69], v[20:21], v[12:13] op_sel_hi:[1,0]
    v_pk_mul_f32 v[70:71], v[22:23], v[12:13] op_sel_hi:[1,0]
    v_pk_mul_f32 v[72:73], v[16:17], v[14:15] op_sel_hi:[1,0]
    v_pk_mul_f32 v[74:75], v[18:19], v[14:15] op_sel_hi:[1,0]
    v_pk_mul_f32 v[76:77], v[20:21], v[14:15] op_sel_hi:[1,0]
    v_pk_mul_f32 v[78:79], v[22:23], v[14:15] op_sel_hi:[1,0]
    v_fract_f32 v65, v65
    v_fract_f32 v67, v67
    v_fract_f32 v69, v69
    v_fract_f32 v71, v71
    v_fract_f32 v73, v73
    v_fract_f32 v75, v75
    v_fract_f32 v77, v77
    v_fract_f32 v79, v79
    v_exp_f32 v64, v64
    v_cos_f32 v80, v65
    v_sin_f32 v81, v65
    v_exp_f32 v66, v66
    v_cos_f32 v82, v67
    v_sin_f32 v83, v67
    v_exp_f32 v68, v68
    v_cos_f32 v84, v69
    v_sin_f32 v85, v69
    v_exp_f32 v70, v70
    v_cos_f32 v86, v71
    v_sin_f32 v87, v71
    v_exp_f32 v72, v72
    v_cos_f32 v88, v73
    v_sin_f32 v89, v73
    v_exp_f32 v74, v74
    v_cos_f32 v90, v75
    v_sin_f32 v91, v75
    v_exp_f32 v76, v76
    v_cos_f32 v92, v77
    v_sin_f32 v93, v77
    v_exp_f32 v78, v78
    v_cos_f32 v94, v79
    v_sin_f32 v95, v79
    v_pk_mul_f32 v[80:81], v[80:81], v[64:65] op_sel_hi:[1,0]
    v_pk_mul_f32 v[82:83], v[82:83], v[66:67] op_sel_hi:[1,0]
    v_pk_mul_f32 v[84:85], v[84:85], v[68:69] op_sel_hi:[1,0]
    v_pk_mul_f32 v[86:87], v[86:87], v[70:71] op_sel_hi:[1,0]
    v_pk_mul_f32 v[88:89], v[88:89], v[72:73] op_sel_hi:[1,0]
    v_pk_mul_f32 v[90:91], v[90:91], v[74:75] op_sel_hi:[1,0]
    v_pk_mul_f32 v[92:93], v[92:93], v[76:77] op_sel_hi:[1,0]
    v_pk_mul_f32 v[94:95], v[94:95], v[78:79] op_sel_hi:[1,0]
    v_pk_mul_f32 v[96:97], v[88:89], v[24:25] op_sel:[0,0] op_sel_hi:[0,1]
    v_pk_mul_f32 v[98:99], v[90:91], v[26:27] op_sel:[0,0] op_sel_hi:[0,1]
    v_pk_mul_f32 v[100:101], v[92:93], v[28:29] op_sel:[0,0] op_sel_hi:[0,1]
    v_pk_mul_f32 v[102:103], v[94:95], v[30:31] op_sel:[0,0] op_sel_hi:[0,1]
    v_cvt_pk_bf16_f32 v112, v80, v81
    v_cvt_pk_bf16_f32 v113, v82, v83
    v_cvt_pk_bf16_f32 v114, v84, v85
    v_cvt_pk_bf16_f32 v115, v86, v87
    v_pk_fma_f32 v[88:89], v[88:89], v[24:25], v[96:97] op_sel:[1,1,0] op_sel_hi:[1,0,1] neg_lo:[0,1,0]
    v_pk_fma_f32 v[90:91], v[90:91], v[26:27], v[98:99] op_sel:[1,1,0] op_sel_hi:[1,0,1] neg_lo:[0,1,0]
    v_pk_fma_f32 v[92:93], v[92:93], v[28:29], v[100:101] op_sel:[1,1,0] op_sel_hi:[1,0,1] neg_lo:[0,1,0]
    v_pk_fma_f32 v[94:95], v[94:95], v[30:31], v[102:103] op_sel:[1,1,0] op_sel_hi:[1,0,1] neg_lo:[0,1,0]
    v_pk_mul_f32 v[96:97], v[80:81], v[32:33] op_sel:[0,0] op_sel_hi:[0,1]
    v_pk_mul_f32 v[98:99], v[82:83], v[34:35] op_sel:[0,0] op_sel_hi:[0,1]
    v_pk_mul_f32 v[100:101], v[84:85], v[36:37] op_sel:[0,0] op_sel_hi:[0,1]
    v_pk_mul_f32 v[102:103], v[86:87], v[38:39] op_sel:[0,0] op_sel_hi:[0,1]
    v_cvt_pk_bf16_f32 v128, v88, -v89
    v_cvt_pk_bf16_f32 v129, v90, -v91
    v_cvt_pk_bf16_f32 v130, v92, -v93
    v_cvt_pk_bf16_f32 v131, v94, -v95
    v_pk_fma_f32 v[80:81], v[80:81], v[32:33], v[96:97] op_sel:[1,1,0] op_sel_hi:[1,0,1] neg_lo:[0,1,0]
    v_pk_fma_f32 v[82:83], v[82:83], v[34:35], v[98:99] op_sel:[1,1,0] op_sel_hi:[1,0,1] neg_lo:[0,1,0]
    v_pk_fma_f32 v[84:85], v[84:85], v[36:37], v[100:101] op_sel:[1,1,0] op_sel_hi:[1,0,1] neg_lo:[0,1,0]
    v_pk_fma_f32 v[86:87], v[86:87], v[38:39], v[102:103] op_sel:[1,1,0] op_sel_hi:[1,0,1] neg_lo:[0,1,0]
    v_mfma_f32_16x16x32_bf16 v[160:163], v[112:115], v[128:131], 0
    v_cvt_pk_bf16_f32 v116, v80, v81
    v_cvt_pk_bf16_f32 v117, v82, v83
    v_cvt_pk_bf16_f32 v118, v84, v85
    v_cvt_pk_bf16_f32 v119, v86, v87
    v_pk_mul_f32 v[96:97], v[80:81], v[32:33] op_sel:[0,0] op_sel_hi:[0,1]
    v_pk_mul_f32 v[98:99], v[82:83], v[34:35] op_sel:[0,0] op_sel_hi:[0,1]
    v_pk_mul_f32 v[100:101], v[84:85], v[36:37] op_sel:[0,0] op_sel_hi:[0,1]
    v_pk_mul_f32 v[102:103], v[86:87], v[38:39] op_sel:[0,0] op_sel_hi:[0,1]
    v_pk_fma_f32 v[80:81], v[80:81], v[32:33], v[96:97] op_sel:[1,1,0] op_sel_hi:[1,0,1] neg_lo:[0,1,0]
    v_pk_fma_f32 v[82:83], v[82:83], v[34:35], v[98:99] op_sel:[1,1,0] op_sel_hi:[1,0,1] neg_lo:[0,1,0]
    v_pk_fma_f32 v[84:85], v[84:85], v[36:37], v[100:101] op_sel:[1,1,0] op_sel_hi:[1,0,1] neg_lo:[0,1,0]
    v_pk_fma_f32 v[86:87], v[86:87], v[38:39], v[102:103] op_sel:[1,1,0] op_sel_hi:[1,0,1] neg_lo:[0,1,0]
    v_mfma_f32_16x16x32_bf16 v[164:167], v[116:119], v[128:131], 0
    v_cvt_pk_bf16_f32 v120, v80, v81
    v_cvt_pk_bf16_f32 v121, v82, v83
    v_cvt_pk_bf16_f32 v122, v84, v85
    v_cvt_pk_bf16_f32 v123, v86, v87
    v_pk_mul_f32 v[96:97], v[80:81], v[32:33] op_sel:[0,0] op_sel_hi:[0,1]
    v_pk_mul_f32 v[98:99], v[82:83], v[34:35] op_sel:[0,0] op_sel_hi:[0,1]
    v_pk_mul_f32 v[100:101], v[84:85], v[36:37] op_sel:[0,0] op_sel_hi:[0,1]
    v_pk_mul_f32 v[102:103], v[86:87], v[38:39] op_sel:[0,0] op_sel_hi:[0,1]
    v_pk_fma_f32 v[80:81], v[80:81], v[32:33], v[96:97] op_sel:[1,1,0] op_sel_hi:[1,0,1] neg_lo:[0,1,0]
    v_pk_fma_f32 v[82:83], v[82:83], v[34:35], v[98:99] op_sel:[1,1,0] op_sel_hi:[1,0,1] neg_lo:[0,1,0]
    v_pk_fma_f32 v[84:85], v[84:85], v[36:37], v[100:101] op_sel:[1,1,0] op_sel_hi:[1,0,1] neg_lo:[0,1,0]
    v_pk_fma_f32 v[86:87], v[86:87], v[38:39], v[102:103] op_sel:[1,1,0] op_sel_hi:[1,0,1] neg_lo:[0,1,0]
    v_mfma_f32_16x16x32_bf16 v[168:171], v[120:123], v[128:131], 0
    v_cvt_pk_bf16_f32 v124, v80, v81
    v_cvt_pk_bf16_f32 v125, v82, v83
    v_cvt_pk_bf16_f32 v126, v84, v85
    v_cvt_pk_bf16_f32 v127, v86, v87
    s_nop 1
    v_mfma_f32_16x16x32_bf16 v[172:175], v[124:127], v[128:131], 0
    ds_read_b128 v[16:19], v6 offset:26624
    ds_read_b128 v[20:23], v6 offset:26640
    ds_read_b128 v[24:27], v6 offset:27648
    ds_read_b128 v[28:31], v6 offset:27664
    ds_read_b128 v[32:35], v6 offset:28672
    ds_read_b128 v[36:39], v6 offset:28688
    s_waitcnt lgkmcnt(6)
    v_pk_mul_f32 v[64:65], v[40:41], v[12:13] op_sel_hi:[1,0]
    v_pk_mul_f32 v[66:67], v[42:43], v[12:13] op_sel_hi:[1,0]
    v_pk_mul_f32 v[68:69], v[44:45], v[12:13] op_sel_hi:[1,0]
    v_pk_mul_f32 v[70:71], v[46:47], v[12:13] op_sel_hi:[1,0]
    v_pk_mul_f32 v[72:73], v[40:41], v[14:15] op_sel_hi:[1,0]
    v_pk_mul_f32 v[74:75], v[42:43], v[14:15] op_sel_hi:[1,0]
    v_pk_mul_f32 v[76:77], v[44:45], v[14:15] op_sel_hi:[1,0]
    v_pk_mul_f32 v[78:79], v[46:47], v[14:15] op_sel_hi:[1,0]
    v_fract_f32 v65, v65
    v_fract_f32 v67, v67
    v_fract_f32 v69, v69
    v_fract_f32 v71, v71
    v_fract_f32 v73, v73
    v_fract_f32 v75, v75
    v_fract_f32 v77, v77
    v_fract_f32 v79, v79
    v_exp_f32 v64, v64
    v_cos_f32 v80, v65
    v_sin_f32 v81, v65
    v_exp_f32 v66, v66
    v_cos_f32 v82, v67
    v_sin_f32 v83, v67
    v_exp_f32 v68, v68
    v_cos_f32 v84, v69
    v_sin_f32 v85, v69
    v_exp_f32 v70, v70
    v_cos_f32 v86, v71
    v_sin_f32 v87, v71
    v_exp_f32 v72, v72
    v_cos_f32 v88, v73
    v_sin_f32 v89, v73
    v_exp_f32 v74, v74
    v_cos_f32 v90, v75
    v_sin_f32 v91, v75
    v_exp_f32 v76, v76
    v_cos_f32 v92, v77
    v_sin_f32 v93, v77
    v_exp_f32 v78, v78
    v_cos_f32 v94, v79
    v_sin_f32 v95, v79
    v_pk_mul_f32 v[80:81], v[80:81], v[64:65] op_sel_hi:[1,0]
    v_pk_mul_f32 v[82:83], v[82:83], v[66:67] op_sel_hi:[1,0]
    v_pk_mul_f32 v[84:85], v[84:85], v[68:69] op_sel_hi:[1,0]
    v_pk_mul_f32 v[86:87], v[86:87], v[70:71] op_sel_hi:[1,0]
    v_pk_mul_f32 v[88:89], v[88:89], v[72:73] op_sel_hi:[1,0]
    v_pk_mul_f32 v[90:91], v[90:91], v[74:75] op_sel_hi:[1,0]
    v_pk_mul_f32 v[92:93], v[92:93], v[76:77] op_sel_hi:[1,0]
    v_pk_mul_f32 v[94:95], v[94:95], v[78:79] op_sel_hi:[1,0]
    v_pk_mul_f32 v[96:97], v[88:89], v[48:49] op_sel:[0,0] op_sel_hi:[0,1]
    v_pk_mul_f32 v[98:99], v[90:91], v[50:51] op_sel:[0,0] op_sel_hi:[0,1]
    v_pk_mul_f32 v[100:101], v[92:93], v[52:53] op_sel:[0,0] op_sel_hi:[0,1]
    v_pk_mul_f32 v[102:103], v[94:95], v[54:55] op_sel:[0,0] op_sel_hi:[0,1]
    v_cvt_pk_bf16_f32 v132, v80, v81
    v_cvt_pk_bf16_f32 v133, v82, v83
    v_cvt_pk_bf16_f32 v134, v84, v85
    v_cvt_pk_bf16_f32 v135, v86, v87
    v_pk_fma_f32 v[88:89], v[88:89], v[48:49], v[96:97] op_sel:[1,1,0] op_sel_hi:[1,0,1] neg_lo:[0,1,0]
    v_pk_fma_f32 v[90:91], v[90:91], v[50:51], v[98:99] op_sel:[1,1,0] op_sel_hi:[1,0,1] neg_lo:[0,1,0]
    v_pk_fma_f32 v[92:93], v[92:93], v[52:53], v[100:101] op_sel:[1,1,0] op_sel_hi:[1,0,1] neg_lo:[0,1,0]
    v_pk_fma_f32 v[94:95], v[94:95], v[54:55], v[102:103] op_sel:[1,1,0] op_sel_hi:[1,0,1] neg_lo:[0,1,0]
    v_pk_mul_f32 v[96:97], v[80:81], v[56:57] op_sel:[0,0] op_sel_hi:[0,1]
    v_pk_mul_f32 v[98:99], v[82:83], v[58:59] op_sel:[0,0] op_sel_hi:[0,1]
    v_pk_mul_f32 v[100:101], v[84:85], v[60:61] op_sel:[0,0] op_sel_hi:[0,1]
    v_pk_mul_f32 v[102:103], v[86:87], v[62:63] op_sel:[0,0] op_sel_hi:[0,1]
    v_cvt_pk_bf16_f32 v148, v88, -v89
    v_cvt_pk_bf16_f32 v149, v90, -v91
    v_cvt_pk_bf16_f32 v150, v92, -v93
    v_cvt_pk_bf16_f32 v151, v94, -v95
    v_pk_fma_f32 v[80:81], v[80:81], v[56:57], v[96:97] op_sel:[1,1,0] op_sel_hi:[1,0,1] neg_lo:[0,1,0]
    v_pk_fma_f32 v[82:83], v[82:83], v[58:59], v[98:99] op_sel:[1,1,0] op_sel_hi:[1,0,1] neg_lo:[0,1,0]
    v_pk_fma_f32 v[84:85], v[84:85], v[60:61], v[100:101] op_sel:[1,1,0] op_sel_hi:[1,0,1] neg_lo:[0,1,0]
    v_pk_fma_f32 v[86:87], v[86:87], v[62:63], v[102:103] op_sel:[1,1,0] op_sel_hi:[1,0,1] neg_lo:[0,1,0]
    v_mfma_f32_16x16x32_bf16 v[160:163], v[132:135], v[148:151], v[160:163]
    v_cvt_pk_bf16_f32 v136, v80, v81
    v_cvt_pk_bf16_f32 v137, v82, v83
    v_cvt_pk_bf16_f32 v138, v84, v85
    v_cvt_pk_bf16_f32 v139, v86, v87
    v_pk_mul_f32 v[96:97], v[80:81], v[56:57] op_sel:[0,0] op_sel_hi:[0,1]
    v_pk_mul_f32 v[98:99], v[82:83], v[58:59] op_sel:[0,0] op_sel_hi:[0,1]
    v_pk_mul_f32 v[100:101], v[84:85], v[60:61] op_sel:[0,0] op_sel_hi:[0,1]
    v_pk_mul_f32 v[102:103], v[86:87], v[62:63] op_sel:[0,0] op_sel_hi:[0,1]
    v_pk_fma_f32 v[80:81], v[80:81], v[56:57], v[96:97] op_sel:[1,1,0] op_sel_hi:[1,0,1] neg_lo:[0,1,0]
    v_pk_fma_f32 v[82:83], v[82:83], v[58:59], v[98:99] op_sel:[1,1,0] op_sel_hi:[1,0,1] neg_lo:[0,1,0]
    v_pk_fma_f32 v[84:85], v[84:85], v[60:61], v[100:101] op_sel:[1,1,0] op_sel_hi:[1,0,1] neg_lo:[0,1,0]
    v_pk_fma_f32 v[86:87], v[86:87], v[62:63], v[102:103] op_sel:[1,1,0] op_sel_hi:[1,0,1] neg_lo:[0,1,0]
    v_mfma_f32_16x16x32_bf16 v[164:167], v[136:139], v[148:151], v[164:167]
    v_cvt_pk_bf16_f32 v140, v80, v81
    v_cvt_pk_bf16_f32 v141, v82, v83
    v_cvt_pk_bf16_f32 v142, v84, v85
    v_cvt_pk_bf16_f32 v143, v86, v87
    v_pk_mul_f32 v[96:97], v[80:81], v[56:57] op_sel:[0,0] op_sel_hi:[0,1]
    v_pk_mul_f32 v[98:99], v[82:83], v[58:59] op_sel:[0,0] op_sel_hi:[0,1]
    v_pk_mul_f32 v[100:101], v[84:85], v[60:61] op_sel:[0,0] op_sel_hi:[0,1]
    v_pk_mul_f32 v[102:103], v[86:87], v[62:63] op_sel:[0,0] op_sel_hi:[0,1]
    v_pk_fma_f32 v[80:81], v[80:81], v[56:57], v[96:97] op_sel:[1,1,0] op_sel_hi:[1,0,1] neg_lo:[0,1,0]
    v_pk_fma_f32 v[82:83], v[82:83], v[58:59], v[98:99] op_sel:[1,1,0] op_sel_hi:[1,0,1] neg_lo:[0,1,0]
    v_pk_fma_f32 v[84:85], v[84:85], v[60:61], v[100:101] op_sel:[1,1,0] op_sel_hi:[1,0,1] neg_lo:[0,1,0]
    v_pk_fma_f32 v[86:87], v[86:87], v[62:63], v[102:103] op_sel:[1,1,0] op_sel_hi:[1,0,1] neg_lo:[0,1,0]
    v_mfma_f32_16x16x32_bf16 v[168:171], v[140:143], v[148:151], v[168:171]
    v_cvt_pk_bf16_f32 v144, v80, v81
    v_cvt_pk_bf16_f32 v145, v82, v83
    v_cvt_pk_bf16_f32 v146, v84, v85
    v_cvt_pk_bf16_f32 v147, v86, v87
    s_nop 1
    v_mfma_f32_16x16x32_bf16 v[172:175], v[144:147], v[148:151], v[172:175]
    s_waitcnt vmcnt(0)
    s_mov_b32 s61, 0
NL5:
    v_readfirstlane_b32 s60, v252
    s_nop 0
    s_cmp_lg_u32 s60, 0
    s_cbranch_scc1 ND5
    s_add_u32 s61, s61, 1
    s_cmp_gt_u32 s61, 100000
    s_cbranch_scc1 ND5
    buffer_load_dword v252, off, s[40:43], 0 sc1
    s_waitcnt vmcnt(0)
    s_branch NL5
ND5:
    s_nop 1
    s_lshl_b32 s49, s62, 2
    s_add_u32 s49, s49, s3
    s_lshl_b32 s49, s49, 7
    s_add_u32 s49, s49, 3260416
    v_mov_b32 v252, s60
    buffer_store_dword v252, off, s[32:35], s49 sc1
    s_setprio 1
    ds_read_b128 v[40:43], v6 offset:26752
    ds_read_b128 v[44:47], v6 offset:26768
    ds_read_b128 v[48:51], v6 offset:27776
    ds_read_b128 v[52:55], v6 offset:27792
    ds_read_b128 v[56:59], v6 offset:28800
    ds_read_b128 v[60:63], v6 offset:28816
    s_waitcnt lgkmcnt(6)
    v_pk_mul_f32 v[64:65], v[16:17], v[12:13] op_sel_hi:[1,0]
    v_pk_mul_f32 v[66:67], v[18:19], v[12:13] op_sel_hi:[1,0]
    v_pk_mul_f32 v[68:69], v[20:21], v[12:13] op_sel_hi:[1,0]
    v_pk_mul_f32 v[70:71], v[22:23], v[12:13] op_sel_hi:[1,0]
    v_pk_mul_f32 v[72:73], v[16:17], v[14:15] op_sel_hi:[1,0]
    v_pk_mul_f32 v[74:75], v[18:19], v[14:15] op_sel_hi:[1,0]
    v_pk_mul_f32 v[76:77], v[20:21], v[14:15] op_sel_hi:[1,0]
    v_pk_mul_f32 v[78:79], v[22:23], v[14:15] op_sel_hi:[1,0]
    v_fract_f32 v65, v65
    v_fract_f32 v67, v67
    v_fract_f32 v69, v69
    v_fract_f32 v71, v71
    v_fract_f32 v73, v73
    v_fract_f32 v75, v75
    v_fract_f32 v77, v77
    v_fract_f32 v79, v79
    v_exp_f32 v64, v64
    v_cos_f32 v80, v65
    v_sin_f32 v81, v65
    v_exp_f32 v66, v66
    v_cos_f32 v82, v67
    v_sin_f32 v83, v67
    v_exp_f32 v68, v68
    v_cos_f32 v84, v69
    v_sin_f32 v85, v69
    v_exp_f32 v70, v70
    v_cos_f32 v86, v71
    v_sin_f32 v87, v71
    v_exp_f32 v72, v72
    v_cos_f32 v88, v73
    v_sin_f32 v89, v73
    v_exp_f32 v74, v74
    v_cos_f32 v90, v75
    v_sin_f32 v91, v75
    v_exp_f32 v76, v76
    v_cos_f32 v92, v77
    v_sin_f32 v93, v77
    v_exp_f32 v78, v78
    v_cos_f32 v94, v79
    v_sin_f32 v95, v79
    v_pk_mul_f32 v[80:81], v[80:81], v[64:65] op_sel_hi:[1,0]
    v_pk_mul_f32 v[82:83], v[82:83], v[66:67] op_sel_hi:[1,0]
    v_pk_mul_f32 v[84:85], v[84:85], v[68:69] op_sel_hi:[1,0]
    v_pk_mul_f32 v[86:87], v[86:87], v[70:71] op_sel_hi:[1,0]
    v_pk_mul_f32 v[88:89], v[88:89], v[72:73] op_sel_hi:[1,0]
    v_pk_mul_f32 v[90:91], v[90:91], v[74:75] op_sel_hi:[1,0]
    v_pk_mul_f32 v[92:93], v[92:93], v[76:77] op_sel_hi:[1,0]
    v_pk_mul_f32 v[94:95], v[94:95], v[78:79] op_sel_hi:[1,0]
    v_pk_mul_f32 v[96:97], v[88:89], v[24:25] op_sel:[0,0] op_sel_hi:[0,1]
    v_pk_mul_f32 v[98:99], v[90:91], v[26:27] op_sel:[0,0] op_sel_hi:[0,1]
    v_pk_mul_f32 v[100:101], v[92:93], v[28:29] op_sel:[0,0] op_sel_hi:[0,1]
    v_pk_mul_f32 v[102:103], v[94:95], v[30:31] op_sel:[0,0] op_sel_hi:[0,1]
    v_cvt_pk_bf16_f32 v112, v80, v81
    v_cvt_pk_bf16_f32 v113, v82, v83
    v_cvt_pk_bf16_f32 v114, v84, v85
    v_cvt_pk_bf16_f32 v115, v86, v87
    v_pk_fma_f32 v[88:89], v[88:89], v[24:25], v[96:97] op_sel:[1,1,0] op_sel_hi:[1,0,1] neg_lo:[0,1,0]
    v_pk_fma_f32 v[90:91], v[90:91], v[26:27], v[98:99] op_sel:[1,1,0] op_sel_hi:[1,0,1] neg_lo:[0,1,0]
    v_pk_fma_f32 v[92:93], v[92:93], v[28:29], v[100:101] op_sel:[1,1,0] op_sel_hi:[1,0,1] neg_lo:[0,1,0]
    v_pk_fma_f32 v[94:95], v[94:95], v[30:31], v[102:103] op_sel:[1,1,0] op_sel_hi:[1,0,1] neg_lo:[0,1,0]
    v_pk_mul_f32 v[96:97], v[80:81], v[32:33] op_sel:[0,0] op_sel_hi:[0,1]
    v_pk_mul_f32 v[98:99], v[82:83], v[34:35] op_sel:[0,0] op_sel_hi:[0,1]
    v_pk_mul_f32 v[100:101], v[84:85], v[36:37] op_sel:[0,0] op_sel_hi:[0,1]
    v_pk_mul_f32 v[102:103], v[86:87], v[38:39] op_sel:[0,0] op_sel_hi:[0,1]
    v_cvt_pk_bf16_f32 v128, v88, -v89
    v_cvt_pk_bf16_f32 v129, v90, -v91
    v_cvt_pk_bf16_f32 v130, v92, -v93
    v_cvt_pk_bf16_f32 v131, v94, -v95
    v_pk_fma_f32 v[80:81], v[80:81], v[32:33], v[96:97] op_sel:[1,1,0] op_sel_hi:[1,0,1] neg_lo:[0,1,0]
    v_pk_fma_f32 v[82:83], v[82:83], v[34:35], v[98:99] op_sel:[1,1,0] op_sel_hi:[1,0,1] neg_lo:[0,1,0]
    v_pk_fma_f32 v[84:85], v[84:85], v[36:37], v[100:101] op_sel:[1,1,0] op_sel_hi:[1,0,1] neg_lo:[0,1,0]
    v_pk_fma_f32 v[86:87], v[86:87], v[38:39], v[102:103] op_sel:[1,1,0] op_sel_hi:[1,0,1] neg_lo:[0,1,0]
    v_mfma_f32_16x16x32_bf16 v[160:163], v[112:115], v[128:131], v[160:163]
    v_cvt_pk_bf16_f32 v116, v80, v81
    v_cvt_pk_bf16_f32 v117, v82, v83
    v_cvt_pk_bf16_f32 v118, v84, v85
    v_cvt_pk_bf16_f32 v119, v86, v87
    v_pk_mul_f32 v[96:97], v[80:81], v[32:33] op_sel:[0,0] op_sel_hi:[0,1]
    v_pk_mul_f32 v[98:99], v[82:83], v[34:35] op_sel:[0,0] op_sel_hi:[0,1]
    v_pk_mul_f32 v[100:101], v[84:85], v[36:37] op_sel:[0,0] op_sel_hi:[0,1]
    v_pk_mul_f32 v[102:103], v[86:87], v[38:39] op_sel:[0,0] op_sel_hi:[0,1]
    v_pk_fma_f32 v[80:81], v[80:81], v[32:33], v[96:97] op_sel:[1,1,0] op_sel_hi:[1,0,1] neg_lo:[0,1,0]
    v_pk_fma_f32 v[82:83], v[82:83], v[34:35], v[98:99] op_sel:[1,1,0] op_sel_hi:[1,0,1] neg_lo:[0,1,0]
    v_pk_fma_f32 v[84:85], v[84:85], v[36:37], v[100:101] op_sel:[1,1,0] op_sel_hi:[1,0,1] neg_lo:[0,1,0]
    v_pk_fma_f32 v[86:87], v[86:87], v[38:39], v[102:103] op_sel:[1,1,0] op_sel_hi:[1,0,1] neg_lo:[0,1,0]
    v_mfma_f32_16x16x32_bf16 v[164:167], v[116:119], v[128:131], v[164:167]
    v_cvt_pk_bf16_f32 v120, v80, v81
    v_cvt_pk_bf16_f32 v121, v82, v83
    v_cvt_pk_bf16_f32 v122, v84, v85
    v_cvt_pk_bf16_f32 v123, v86, v87
    v_pk_mul_f32 v[96:97], v[80:81], v[32:33] op_sel:[0,0] op_sel_hi:[0,1]
    v_pk_mul_f32 v[98:99], v[82:83], v[34:35] op_sel:[0,0] op_sel_hi:[0,1]
    v_pk_mul_f32 v[100:101], v[84:85], v[36:37] op_sel:[0,0] op_sel_hi:[0,1]
    v_pk_mul_f32 v[102:103], v[86:87], v[38:39] op_sel:[0,0] op_sel_hi:[0,1]
    v_pk_fma_f32 v[80:81], v[80:81], v[32:33], v[96:97] op_sel:[1,1,0] op_sel_hi:[1,0,1] neg_lo:[0,1,0]
    v_pk_fma_f32 v[82:83], v[82:83], v[34:35], v[98:99] op_sel:[1,1,0] op_sel_hi:[1,0,1] neg_lo:[0,1,0]
    v_pk_fma_f32 v[84:85], v[84:85], v[36:37], v[100:101] op_sel:[1,1,0] op_sel_hi:[1,0,1] neg_lo:[0,1,0]
    v_pk_fma_f32 v[86:87], v[86:87], v[38:39], v[102:103] op_sel:[1,1,0] op_sel_hi:[1,0,1] neg_lo:[0,1,0]
    v_mfma_f32_16x16x32_bf16 v[168:171], v[120:123], v[128:131], v[168:171]
    v_cvt_pk_bf16_f32 v124, v80, v81
    v_cvt_pk_bf16_f32 v125, v82, v83
    v_cvt_pk_bf16_f32 v126, v84, v85
    v_cvt_pk_bf16_f32 v127, v86, v87
    s_nop 1
    v_mfma_f32_16x16x32_bf16 v[172:175], v[124:127], v[128:131], v[172:175]
    ds_read_b128 v[16:19], v6 offset:26880
    ds_read_b128 v[20:23], v6 offset:26896
    ds_read_b128 v[24:27], v6 offset:27904
    ds_read_b128 v[28:31], v6 offset:27920
    ds_read_b128 v[32:35], v6 offset:28928
    ds_read_b128 v[36:39], v6 offset:28944
    s_waitcnt lgkmcnt(6)
    v_pk_mul_f32 v[64:65], v[40:41], v[12:13] op_sel_hi:[1,0]
    v_pk_mul_f32 v[66:67], v[42:43], v[12:13] op_sel_hi:[1,0]
    v_pk_mul_f32 v[68:69], v[44:45], v[12:13] op_sel_hi:[1,0]
    v_pk_mul_f32 v[70:71], v[46:47], v[12:13] op_sel_hi:[1,0]
    v_pk_mul_f32 v[72:73], v[40:41], v[14:15] op_sel_hi:[1,0]
    v_pk_mul_f32 v[74:75], v[42:43], v[14:15] op_sel_hi:[1,0]
    v_pk_mul_f32 v[76:77], v[44:45], v[14:15] op_sel_hi:[1,0]
    v_pk_mul_f32 v[78:79], v[46:47], v[14:15] op_sel_hi:[1,0]
    v_fract_f32 v65, v65
    v_fract_f32 v67, v67
    v_fract_f32 v69, v69
    v_fract_f32 v71, v71
    v_fract_f32 v73, v73
    v_fract_f32 v75, v75
    v_fract_f32 v77, v77
    v_fract_f32 v79, v79
    v_exp_f32 v64, v64
    v_cos_f32 v80, v65
    v_sin_f32 v81, v65
    v_exp_f32 v66, v66
    v_cos_f32 v82, v67
    v_sin_f32 v83, v67
    v_exp_f32 v68, v68
    v_cos_f32 v84, v69
    v_sin_f32 v85, v69
    v_exp_f32 v70, v70
    v_cos_f32 v86, v71
    v_sin_f32 v87, v71
    v_exp_f32 v72, v72
    v_cos_f32 v88, v73
    v_sin_f32 v89, v73
    v_exp_f32 v74, v74
    v_cos_f32 v90, v75
    v_sin_f32 v91, v75
    v_exp_f32 v76, v76
    v_cos_f32 v92, v77
    v_sin_f32 v93, v77
    v_exp_f32 v78, v78
    v_cos_f32 v94, v79
    v_sin_f32 v95, v79
    v_pk_mul_f32 v[80:81], v[80:81], v[64:65] op_sel_hi:[1,0]
    v_pk_mul_f32 v[82:83], v[82:83], v[66:67] op_sel_hi:[1,0]
    v_pk_mul_f32 v[84:85], v[84:85], v[68:69] op_sel_hi:[1,0]
    v_pk_mul_f32 v[86:87], v[86:87], v[70:71] op_sel_hi:[1,0]
    v_pk_mul_f32 v[88:89], v[88:89], v[72:73] op_sel_hi:[1,0]
    v_pk_mul_f32 v[90:91], v[90:91], v[74:75] op_sel_hi:[1,0]
    v_pk_mul_f32 v[92:93], v[92:93], v[76:77] op_sel_hi:[1,0]
    v_pk_mul_f32 v[94:95], v[94:95], v[78:79] op_sel_hi:[1,0]
    v_pk_mul_f32 v[96:97], v[88:89], v[48:49] op_sel:[0,0] op_sel_hi:[0,1]
    v_pk_mul_f32 v[98:99], v[90:91], v[50:51] op_sel:[0,0] op_sel_hi:[0,1]
    v_pk_mul_f32 v[100:101], v[92:93], v[52:53] op_sel:[0,0] op_sel_hi:[0,1]
    v_pk_mul_f32 v[102:103], v[94:95], v[54:55] op_sel:[0,0] op_sel_hi:[0,1]
    v_cvt_pk_bf16_f32 v132, v80, v81
    v_cvt_pk_bf16_f32 v133, v82, v83
    v_cvt_pk_bf16_f32 v134, v84, v85
    v_cvt_pk_bf16_f32 v135, v86, v87
    v_pk_fma_f32 v[88:89], v[88:89], v[48:49], v[96:97] op_sel:[1,1,0] op_sel_hi:[1,0,1] neg_lo:[0,1,0]
    v_pk_fma_f32 v[90:91], v[90:91], v[50:51], v[98:99] op_sel:[1,1,0] op_sel_hi:[1,0,1] neg_lo:[0,1,0]
    v_pk_fma_f32 v[92:93], v[92:93], v[52:53], v[100:101] op_sel:[1,1,0] op_sel_hi:[1,0,1] neg_lo:[0,1,0]
    v_pk_fma_f32 v[94:95], v[94:95], v[54:55], v[102:103] op_sel:[1,1,0] op_sel_hi:[1,0,1] neg_lo:[0,1,0]
    v_pk_mul_f32 v[96:97], v[80:81], v[56:57] op_sel:[0,0] op_sel_hi:[0,1]
    v_pk_mul_f32 v[98:99], v[82:83], v[58:59] op_sel:[0,0] op_sel_hi:[0,1]
    v_pk_mul_f32 v[100:101], v[84:85], v[60:61] op_sel:[0,0] op_sel_hi:[0,1]
    v_pk_mul_f32 v[102:103], v[86:87], v[62:63] op_sel:[0,0] op_sel_hi:[0,1]
    v_cvt_pk_bf16_f32 v148, v88, -v89
    v_cvt_pk_bf16_f32 v149, v90, -v91
    v_cvt_pk_bf16_f32 v150, v92, -v93
    v_cvt_pk_bf16_f32 v151, v94, -v95
    v_pk_fma_f32 v[80:81], v[80:81], v[56:57], v[96:97] op_sel:[1,1,0] op_sel_hi:[1,0,1] neg_lo:[0,1,0]
    v_pk_fma_f32 v[82:83], v[82:83], v[58:59], v[98:99] op_sel:[1,1,0] op_sel_hi:[1,0,1] neg_lo:[0,1,0]
    v_pk_fma_f32 v[84:85], v[84:85], v[60:61], v[100:101] op_sel:[1,1,0] op_sel_hi:[1,0,1] neg_lo:[0,1,0]
    v_pk_fma_f32 v[86:87], v[86:87], v[62:63], v[102:103] op_sel:[1,1,0] op_sel_hi:[1,0,1] neg_lo:[0,1,0]
    v_mfma_f32_16x16x32_bf16 v[160:163], v[132:135], v[148:151], v[160:163]
    v_cvt_pk_bf16_f32 v136, v80, v81
    v_cvt_pk_bf16_f32 v137, v82, v83
    v_cvt_pk_bf16_f32 v138, v84, v85
    v_cvt_pk_bf16_f32 v139, v86, v87
    v_pk_mul_f32 v[96:97], v[80:81], v[56:57] op_sel:[0,0] op_sel_hi:[0,1]
    v_pk_mul_f32 v[98:99], v[82:83], v[58:59] op_sel:[0,0] op_sel_hi:[0,1]
    v_pk_mul_f32 v[100:101], v[84:85], v[60:61] op_sel:[0,0] op_sel_hi:[0,1]
    v_pk_mul_f32 v[102:103], v[86:87], v[62:63] op_sel:[0,0] op_sel_hi:[0,1]
    v_pk_fma_f32 v[80:81], v[80:81], v[56:57], v[96:97] op_sel:[1,1,0] op_sel_hi:[1,0,1] neg_lo:[0,1,0]
    v_pk_fma_f32 v[82:83], v[82:83], v[58:59], v[98:99] op_sel:[1,1,0] op_sel_hi:[1,0,1] neg_lo:[0,1,0]
    v_pk_fma_f32 v[84:85], v[84:85], v[60:61], v[100:101] op_sel:[1,1,0] op_sel_hi:[1,0,1] neg_lo:[0,1,0]
    v_pk_fma_f32 v[86:87], v[86:87], v[62:63], v[102:103] op_sel:[1,1,0] op_sel_hi:[1,0,1] neg_lo:[0,1,0]
    v_mfma_f32_16x16x32_bf16 v[164:167], v[136:139], v[148:151], v[164:167]
    v_cvt_pk_bf16_f32 v140, v80, v81
    v_cvt_pk_bf16_f32 v141, v82, v83
    v_cvt_pk_bf16_f32 v142, v84, v85
    v_cvt_pk_bf16_f32 v143, v86, v87
    v_pk_mul_f32 v[96:97], v[80:81], v[56:57] op_sel:[0,0] op_sel_hi:[0,1]
    v_pk_mul_f32 v[98:99], v[82:83], v[58:59] op_sel:[0,0] op_sel_hi:[0,1]
    v_pk_mul_f32 v[100:101], v[84:85], v[60:61] op_sel:[0,0] op_sel_hi:[0,1]
    v_pk_mul_f32 v[102:103], v[86:87], v[62:63] op_sel:[0,0] op_sel_hi:[0,1]
    v_pk_fma_f32 v[80:81], v[80:81], v[56:57], v[96:97] op_sel:[1,1,0] op_sel_hi:[1,0,1] neg_lo:[0,1,0]
    v_pk_fma_f32 v[82:83], v[82:83], v[58:59], v[98:99] op_sel:[1,1,0] op_sel_hi:[1,0,1] neg_lo:[0,1,0]
    v_pk_fma_f32 v[84:85], v[84:85], v[60:61], v[100:101] op_sel:[1,1,0] op_sel_hi:[1,0,1] neg_lo:[0,1,0]
    v_pk_fma_f32 v[86:87], v[86:87], v[62:63], v[102:103] op_sel:[1,1,0] op_sel_hi:[1,0,1] neg_lo:[0,1,0]
    v_mfma_f32_16x16x32_bf16 v[168:171], v[140:143], v[148:151], v[168:171]
    v_cvt_pk_bf16_f32 v144, v80, v81
    v_cvt_pk_bf16_f32 v145, v82, v83
    v_cvt_pk_bf16_f32 v146, v84, v85
    v_cvt_pk_bf16_f32 v147, v86, v87
    s_nop 1
    v_mfma_f32_16x16x32_bf16 v[172:175], v[144:147], v[148:151], v[172:175]
    ds_read_b128 v[40:43], v6 offset:27008
    ds_read_b128 v[44:47], v6 offset:27024
    ds_read_b128 v[48:51], v6 offset:28032
    ds_read_b128 v[52:55], v6 offset:28048
    ds_read_b128 v[56:59], v6 offset:29056
    ds_read_b128 v[60:63], v6 offset:29072
    s_waitcnt lgkmcnt(6)
    v_pk_mul_f32 v[64:65], v[16:17], v[12:13] op_sel_hi:[1,0]
    v_pk_mul_f32 v[66:67], v[18:19], v[12:13] op_sel_hi:[1,0]
    v_pk_mul_f32 v[68:69], v[20:21], v[12:13] op_sel_hi:[1,0]
    v_pk_mul_f32 v[70:71], v[22:23], v[12:13] op_sel_hi:[1,0]
    v_pk_mul_f32 v[72:73], v[16:17], v[14:15] op_sel_hi:[1,0]
    v_pk_mul_f32 v[74:75], v[18:19], v[14:15] op_sel_hi:[1,0]
    v_pk_mul_f32 v[76:77], v[20:21], v[14:15] op_sel_hi:[1,0]
    v_pk_mul_f32 v[78:79], v[22:23], v[14:15] op_sel_hi:[1,0]
    v_fract_f32 v65, v65
    v_fract_f32 v67, v67
    v_fract_f32 v69, v69
    v_fract_f32 v71, v71
    v_fract_f32 v73, v73
    v_fract_f32 v75, v75
    v_fract_f32 v77, v77
    v_fract_f32 v79, v79
    v_exp_f32 v64, v64
    v_cos_f32 v80, v65
    v_sin_f32 v81, v65
    v_exp_f32 v66, v66
    v_cos_f32 v82, v67
    v_sin_f32 v83, v67
    v_exp_f32 v68, v68
    v_cos_f32 v84, v69
    v_sin_f32 v85, v69
    v_exp_f32 v70, v70
    v_cos_f32 v86, v71
    v_sin_f32 v87, v71
    v_exp_f32 v72, v72
    v_cos_f32 v88, v73
    v_sin_f32 v89, v73
    v_exp_f32 v74, v74
    v_cos_f32 v90, v75
    v_sin_f32 v91, v75
    v_exp_f32 v76, v76
    v_cos_f32 v92, v77
    v_sin_f32 v93, v77
    v_exp_f32 v78, v78
    v_cos_f32 v94, v79
    v_sin_f32 v95, v79
    v_pk_mul_f32 v[80:81], v[80:81], v[64:65] op_sel_hi:[1,0]
    v_pk_mul_f32 v[82:83], v[82:83], v[66:67] op_sel_hi:[1,0]
    v_pk_mul_f32 v[84:85], v[84:85], v[68:69] op_sel_hi:[1,0]
    v_pk_mul_f32 v[86:87], v[86:87], v[70:71] op_sel_hi:[1,0]
    v_pk_mul_f32 v[88:89], v[88:89], v[72:73] op_sel_hi:[1,0]
    v_pk_mul_f32 v[90:91], v[90:91], v[74:75] op_sel_hi:[1,0]
    v_pk_mul_f32 v[92:93], v[92:93], v[76:77] op_sel_hi:[1,0]
    v_pk_mul_f32 v[94:95], v[94:95], v[78:79] op_sel_hi:[1,0]
    v_pk_mul_f32 v[96:97], v[88:89], v[24:25] op_sel:[0,0] op_sel_hi:[0,1]
    v_pk_mul_f32 v[98:99], v[90:91], v[26:27] op_sel:[0,0] op_sel_hi:[0,1]
    v_pk_mul_f32 v[100:101], v[92:93], v[28:29] op_sel:[0,0] op_sel_hi:[0,1]
    v_pk_mul_f32 v[102:103], v[94:95], v[30:31] op_sel:[0,0] op_sel_hi:[0,1]
    v_cvt_pk_bf16_f32 v112, v80, v81
    v_cvt_pk_bf16_f32 v113, v82, v83
    v_cvt_pk_bf16_f32 v114, v84, v85
    v_cvt_pk_bf16_f32 v115, v86, v87
    v_pk_fma_f32 v[88:89], v[88:89], v[24:25], v[96:97] op_sel:[1,1,0] op_sel_hi:[1,0,1] neg_lo:[0,1,0]
    v_pk_fma_f32 v[90:91], v[90:91], v[26:27], v[98:99] op_sel:[1,1,0] op_sel_hi:[1,0,1] neg_lo:[0,1,0]
    v_pk_fma_f32 v[92:93], v[92:93], v[28:29], v[100:101] op_sel:[1,1,0] op_sel_hi:[1,0,1] neg_lo:[0,1,0]
    v_pk_fma_f32 v[94:95], v[94:95], v[30:31], v[102:103] op_sel:[1,1,0] op_sel_hi:[1,0,1] neg_lo:[0,1,0]
    v_pk_mul_f32 v[96:97], v[80:81], v[32:33] op_sel:[0,0] op_sel_hi:[0,1]
    v_pk_mul_f32 v[98:99], v[82:83], v[34:35] op_sel:[0,0] op_sel_hi:[0,1]
    v_pk_mul_f32 v[100:101], v[84:85], v[36:37] op_sel:[0,0] op_sel_hi:[0,1]
    v_pk_mul_f32 v[102:103], v[86:87], v[38:39] op_sel:[0,0] op_sel_hi:[0,1]
    v_cvt_pk_bf16_f32 v128, v88, -v89
    v_cvt_pk_bf16_f32 v129, v90, -v91
    v_cvt_pk_bf16_f32 v130, v92, -v93
    v_cvt_pk_bf16_f32 v131, v94, -v95
    v_pk_fma_f32 v[80:81], v[80:81], v[32:33], v[96:97] op_sel:[1,1,0] op_sel_hi:[1,0,1] neg_lo:[0,1,0]
    v_pk_fma_f32 v[82:83], v[82:83], v[34:35], v[98:99] op_sel:[1,1,0] op_sel_hi:[1,0,1] neg_lo:[0,1,0]
    v_pk_fma_f32 v[84:85], v[84:85], v[36:37], v[100:101] op_sel:[1,1,0] op_sel_hi:[1,0,1] neg_lo:[0,1,0]
    v_pk_fma_f32 v[86:87], v[86:87], v[38:39], v[102:103] op_sel:[1,1,0] op_sel_hi:[1,0,1] neg_lo:[0,1,0]
    v_mfma_f32_16x16x32_bf16 v[160:163], v[112:115], v[128:131], v[160:163]
    v_cvt_pk_bf16_f32 v116, v80, v81
    v_cvt_pk_bf16_f32 v117, v82, v83
    v_cvt_pk_bf16_f32 v118, v84, v85
    v_cvt_pk_bf16_f32 v119, v86, v87
    v_pk_mul_f32 v[96:97], v[80:81], v[32:33] op_sel:[0,0] op_sel_hi:[0,1]
    v_pk_mul_f32 v[98:99], v[82:83], v[34:35] op_sel:[0,0] op_sel_hi:[0,1]
    v_pk_mul_f32 v[100:101], v[84:85], v[36:37] op_sel:[0,0] op_sel_hi:[0,1]
    v_pk_mul_f32 v[102:103], v[86:87], v[38:39] op_sel:[0,0] op_sel_hi:[0,1]
    v_pk_fma_f32 v[80:81], v[80:81], v[32:33], v[96:97] op_sel:[1,1,0] op_sel_hi:[1,0,1] neg_lo:[0,1,0]
    v_pk_fma_f32 v[82:83], v[82:83], v[34:35], v[98:99] op_sel:[1,1,0] op_sel_hi:[1,0,1] neg_lo:[0,1,0]
    v_pk_fma_f32 v[84:85], v[84:85], v[36:37], v[100:101] op_sel:[1,1,0] op_sel_hi:[1,0,1] neg_lo:[0,1,0]
    v_pk_fma_f32 v[86:87], v[86:87], v[38:39], v[102:103] op_sel:[1,1,0] op_sel_hi:[1,0,1] neg_lo:[0,1,0]
    v_mfma_f32_16x16x32_bf16 v[164:167], v[116:119], v[128:131], v[164:167]
    v_cvt_pk_bf16_f32 v120, v80, v81
    v_cvt_pk_bf16_f32 v121, v82, v83
    v_cvt_pk_bf16_f32 v122, v84, v85
    v_cvt_pk_bf16_f32 v123, v86, v87
    v_pk_mul_f32 v[96:97], v[80:81], v[32:33] op_sel:[0,0] op_sel_hi:[0,1]
    v_pk_mul_f32 v[98:99], v[82:83], v[34:35] op_sel:[0,0] op_sel_hi:[0,1]
    v_pk_mul_f32 v[100:101], v[84:85], v[36:37] op_sel:[0,0] op_sel_hi:[0,1]
    v_pk_mul_f32 v[102:103], v[86:87], v[38:39] op_sel:[0,0] op_sel_hi:[0,1]
    v_pk_fma_f32 v[80:81], v[80:81], v[32:33], v[96:97] op_sel:[1,1,0] op_sel_hi:[1,0,1] neg_lo:[0,1,0]
    v_pk_fma_f32 v[82:83], v[82:83], v[34:35], v[98:99] op_sel:[1,1,0] op_sel_hi:[1,0,1] neg_lo:[0,1,0]
    v_pk_fma_f32 v[84:85], v[84:85], v[36:37], v[100:101] op_sel:[1,1,0] op_sel_hi:[1,0,1] neg_lo:[0,1,0]
    v_pk_fma_f32 v[86:87], v[86:87], v[38:39], v[102:103] op_sel:[1,1,0] op_sel_hi:[1,0,1] neg_lo:[0,1,0]
    v_mfma_f32_16x16x32_bf16 v[168:171], v[120:123], v[128:131], v[168:171]
    v_cvt_pk_bf16_f32 v124, v80, v81
    v_cvt_pk_bf16_f32 v125, v82, v83
    v_cvt_pk_bf16_f32 v126, v84, v85
    v_cvt_pk_bf16_f32 v127, v86, v87
    s_nop 1
    v_mfma_f32_16x16x32_bf16 v[172:175], v[124:127], v[128:131], v[172:175]
    ds_read_b128 v[16:19], v6 offset:27136
    ds_read_b128 v[20:23], v6 offset:27152
    ds_read_b128 v[24:27], v6 offset:28160
    ds_read_b128 v[28:31], v6 offset:28176
    ds_read_b128 v[32:35], v6 offset:29184
    ds_read_b128 v[36:39], v6 offset:29200
    s_waitcnt lgkmcnt(6)
    v_pk_mul_f32 v[64:65], v[40:41], v[12:13] op_sel_hi:[1,0]
    v_pk_mul_f32 v[66:67], v[42:43], v[12:13] op_sel_hi:[1,0]
    v_pk_mul_f32 v[68:69], v[44:45], v[12:13] op_sel_hi:[1,0]
    v_pk_mul_f32 v[70:71], v[46:47], v[12:13] op_sel_hi:[1,0]
    v_pk_mul_f32 v[72:73], v[40:41], v[14:15] op_sel_hi:[1,0]
    v_pk_mul_f32 v[74:75], v[42:43], v[14:15] op_sel_hi:[1,0]
    v_pk_mul_f32 v[76:77], v[44:45], v[14:15] op_sel_hi:[1,0]
    v_pk_mul_f32 v[78:79], v[46:47], v[14:15] op_sel_hi:[1,0]
    v_fract_f32 v65, v65
    v_fract_f32 v67, v67
    v_fract_f32 v69, v69
    v_fract_f32 v71, v71
    v_fract_f32 v73, v73
    v_fract_f32 v75, v75
    v_fract_f32 v77, v77
    v_fract_f32 v79, v79
    v_exp_f32 v64, v64
    v_cos_f32 v80, v65
    v_sin_f32 v81, v65
    v_exp_f32 v66, v66
    v_cos_f32 v82, v67
    v_sin_f32 v83, v67
    v_exp_f32 v68, v68
    v_cos_f32 v84, v69
    v_sin_f32 v85, v69
    v_exp_f32 v70, v70
    v_cos_f32 v86, v71
    v_sin_f32 v87, v71
    v_exp_f32 v72, v72
    v_cos_f32 v88, v73
    v_sin_f32 v89, v73
    v_exp_f32 v74, v74
    v_cos_f32 v90, v75
    v_sin_f32 v91, v75
    v_exp_f32 v76, v76
    v_cos_f32 v92, v77
    v_sin_f32 v93, v77
    v_exp_f32 v78, v78
    v_cos_f32 v94, v79
    v_sin_f32 v95, v79
    v_pk_mul_f32 v[80:81], v[80:81], v[64:65] op_sel_hi:[1,0]
    v_pk_mul_f32 v[82:83], v[82:83], v[66:67] op_sel_hi:[1,0]
    v_pk_mul_f32 v[84:85], v[84:85], v[68:69] op_sel_hi:[1,0]
    v_pk_mul_f32 v[86:87], v[86:87], v[70:71] op_sel_hi:[1,0]
    v_pk_mul_f32 v[88:89], v[88:89], v[72:73] op_sel_hi:[1,0]
    v_pk_mul_f32 v[90:91], v[90:91], v[74:75] op_sel_hi:[1,0]
    v_pk_mul_f32 v[92:93], v[92:93], v[76:77] op_sel_hi:[1,0]
    v_pk_mul_f32 v[94:95], v[94:95], v[78:79] op_sel_hi:[1,0]
    v_pk_mul_f32 v[96:97], v[88:89], v[48:49] op_sel:[0,0] op_sel_hi:[0,1]
    v_pk_mul_f32 v[98:99], v[90:91], v[50:51] op_sel:[0,0] op_sel_hi:[0,1]
    v_pk_mul_f32 v[100:101], v[92:93], v[52:53] op_sel:[0,0] op_sel_hi:[0,1]
    v_pk_mul_f32 v[102:103], v[94:95], v[54:55] op_sel:[0,0] op_sel_hi:[0,1]
    v_cvt_pk_bf16_f32 v132, v80, v81
    v_cvt_pk_bf16_f32 v133, v82, v83
    v_cvt_pk_bf16_f32 v134, v84, v85
    v_cvt_pk_bf16_f32 v135, v86, v87
    v_pk_fma_f32 v[88:89], v[88:89], v[48:49], v[96:97] op_sel:[1,1,0] op_sel_hi:[1,0,1] neg_lo:[0,1,0]
    v_pk_fma_f32 v[90:91], v[90:91], v[50:51], v[98:99] op_sel:[1,1,0] op_sel_hi:[1,0,1] neg_lo:[0,1,0]
    v_pk_fma_f32 v[92:93], v[92:93], v[52:53], v[100:101] op_sel:[1,1,0] op_sel_hi:[1,0,1] neg_lo:[0,1,0]
    v_pk_fma_f32 v[94:95], v[94:95], v[54:55], v[102:103] op_sel:[1,1,0] op_sel_hi:[1,0,1] neg_lo:[0,1,0]
    v_pk_mul_f32 v[96:97], v[80:81], v[56:57] op_sel:[0,0] op_sel_hi:[0,1]
    v_pk_mul_f32 v[98:99], v[82:83], v[58:59] op_sel:[0,0] op_sel_hi:[0,1]
    v_pk_mul_f32 v[100:101], v[84:85], v[60:61] op_sel:[0,0] op_sel_hi:[0,1]
    v_pk_mul_f32 v[102:103], v[86:87], v[62:63] op_sel:[0,0] op_sel_hi:[0,1]
    v_cvt_pk_bf16_f32 v148, v88, -v89
    v_cvt_pk_bf16_f32 v149, v90, -v91
    v_cvt_pk_bf16_f32 v150, v92, -v93
    v_cvt_pk_bf16_f32 v151, v94, -v95
    v_pk_fma_f32 v[80:81], v[80:81], v[56:57], v[96:97] op_sel:[1,1,0] op_sel_hi:[1,0,1] neg_lo:[0,1,0]
    v_pk_fma_f32 v[82:83], v[82:83], v[58:59], v[98:99] op_sel:[1,1,0] op_sel_hi:[1,0,1] neg_lo:[0,1,0]
    v_pk_fma_f32 v[84:85], v[84:85], v[60:61], v[100:101] op_sel:[1,1,0] op_sel_hi:[1,0,1] neg_lo:[0,1,0]
    v_pk_fma_f32 v[86:87], v[86:87], v[62:63], v[102:103] op_sel:[1,1,0] op_sel_hi:[1,0,1] neg_lo:[0,1,0]
    v_mfma_f32_16x16x32_bf16 v[160:163], v[132:135], v[148:151], v[160:163]
    v_cvt_pk_bf16_f32 v136, v80, v81
    v_cvt_pk_bf16_f32 v137, v82, v83
    v_cvt_pk_bf16_f32 v138, v84, v85
    v_cvt_pk_bf16_f32 v139, v86, v87
    v_pk_mul_f32 v[96:97], v[80:81], v[56:57] op_sel:[0,0] op_sel_hi:[0,1]
    v_pk_mul_f32 v[98:99], v[82:83], v[58:59] op_sel:[0,0] op_sel_hi:[0,1]
    v_pk_mul_f32 v[100:101], v[84:85], v[60:61] op_sel:[0,0] op_sel_hi:[0,1]
    v_pk_mul_f32 v[102:103], v[86:87], v[62:63] op_sel:[0,0] op_sel_hi:[0,1]
    v_pk_fma_f32 v[80:81], v[80:81], v[56:57], v[96:97] op_sel:[1,1,0] op_sel_hi:[1,0,1] neg_lo:[0,1,0]
    v_pk_fma_f32 v[82:83], v[82:83], v[58:59], v[98:99] op_sel:[1,1,0] op_sel_hi:[1,0,1] neg_lo:[0,1,0]
    v_pk_fma_f32 v[84:85], v[84:85], v[60:61], v[100:101] op_sel:[1,1,0] op_sel_hi:[1,0,1] neg_lo:[0,1,0]
    v_pk_fma_f32 v[86:87], v[86:87], v[62:63], v[102:103] op_sel:[1,1,0] op_sel_hi:[1,0,1] neg_lo:[0,1,0]
    v_mfma_f32_16x16x32_bf16 v[164:167], v[136:139], v[148:151], v[164:167]
    v_cvt_pk_bf16_f32 v140, v80, v81
    v_cvt_pk_bf16_f32 v141, v82, v83
    v_cvt_pk_bf16_f32 v142, v84, v85
    v_cvt_pk_bf16_f32 v143, v86, v87
    v_pk_mul_f32 v[96:97], v[80:81], v[56:57] op_sel:[0,0] op_sel_hi:[0,1]
    v_pk_mul_f32 v[98:99], v[82:83], v[58:59] op_sel:[0,0] op_sel_hi:[0,1]
    v_pk_mul_f32 v[100:101], v[84:85], v[60:61] op_sel:[0,0] op_sel_hi:[0,1]
    v_pk_mul_f32 v[102:103], v[86:87], v[62:63] op_sel:[0,0] op_sel_hi:[0,1]
    v_pk_fma_f32 v[80:81], v[80:81], v[56:57], v[96:97] op_sel:[1,1,0] op_sel_hi:[1,0,1] neg_lo:[0,1,0]
    v_pk_fma_f32 v[82:83], v[82:83], v[58:59], v[98:99] op_sel:[1,1,0] op_sel_hi:[1,0,1] neg_lo:[0,1,0]
    v_pk_fma_f32 v[84:85], v[84:85], v[60:61], v[100:101] op_sel:[1,1,0] op_sel_hi:[1,0,1] neg_lo:[0,1,0]
    v_pk_fma_f32 v[86:87], v[86:87], v[62:63], v[102:103] op_sel:[1,1,0] op_sel_hi:[1,0,1] neg_lo:[0,1,0]
    v_mfma_f32_16x16x32_bf16 v[168:171], v[140:143], v[148:151], v[168:171]
    v_cvt_pk_bf16_f32 v144, v80, v81
    v_cvt_pk_bf16_f32 v145, v82, v83
    v_cvt_pk_bf16_f32 v146, v84, v85
    v_cvt_pk_bf16_f32 v147, v86, v87
    s_nop 1
    v_mfma_f32_16x16x32_bf16 v[172:175], v[144:147], v[148:151], v[172:175]
    ds_read_b128 v[40:43], v6 offset:27264
    ds_read_b128 v[44:47], v6 offset:27280
    ds_read_b128 v[48:51], v6 offset:28288
    ds_read_b128 v[52:55], v6 offset:28304
    ds_read_b128 v[56:59], v6 offset:29312
    ds_read_b128 v[60:63], v6 offset:29328
    s_waitcnt lgkmcnt(6)
    v_pk_mul_f32 v[64:65], v[16:17], v[12:13] op_sel_hi:[1,0]
    v_pk_mul_f32 v[66:67], v[18:19], v[12:13] op_sel_hi:[1,0]
    v_pk_mul_f32 v[68:69], v[20:21], v[12:13] op_sel_hi:[1,0]
    v_pk_mul_f32 v[70:71], v[22:23], v[12:13] op_sel_hi:[1,0]
    v_pk_mul_f32 v[72:73], v[16:17], v[14:15] op_sel_hi:[1,0]
    v_pk_mul_f32 v[74:75], v[18:19], v[14:15] op_sel_hi:[1,0]
    v_pk_mul_f32 v[76:77], v[20:21], v[14:15] op_sel_hi:[1,0]
    v_pk_mul_f32 v[78:79], v[22:23], v[14:15] op_sel_hi:[1,0]
    v_fract_f32 v65, v65
    v_fract_f32 v67, v67
    v_fract_f32 v69, v69
    v_fract_f32 v71, v71
    v_fract_f32 v73, v73
    v_fract_f32 v75, v75
    v_fract_f32 v77, v77
    v_fract_f32 v79, v79
    v_exp_f32 v64, v64
    v_cos_f32 v80, v65
    v_sin_f32 v81, v65
    v_exp_f32 v66, v66
    v_cos_f32 v82, v67
    v_sin_f32 v83, v67
    v_exp_f32 v68, v68
    v_cos_f32 v84, v69
    v_sin_f32 v85, v69
    v_exp_f32 v70, v70
    v_cos_f32 v86, v71
    v_sin_f32 v87, v71
    v_exp_f32 v72, v72
    v_cos_f32 v88, v73
    v_sin_f32 v89, v73
    v_exp_f32 v74, v74
    v_cos_f32 v90, v75
    v_sin_f32 v91, v75
    v_exp_f32 v76, v76
    v_cos_f32 v92, v77
    v_sin_f32 v93, v77
    v_exp_f32 v78, v78
    v_cos_f32 v94, v79
    v_sin_f32 v95, v79
    v_pk_mul_f32 v[80:81], v[80:81], v[64:65] op_sel_hi:[1,0]
    v_pk_mul_f32 v[82:83], v[82:83], v[66:67] op_sel_hi:[1,0]
    v_pk_mul_f32 v[84:85], v[84:85], v[68:69] op_sel_hi:[1,0]
    v_pk_mul_f32 v[86:87], v[86:87], v[70:71] op_sel_hi:[1,0]
    v_pk_mul_f32 v[88:89], v[88:89], v[72:73] op_sel_hi:[1,0]
    v_pk_mul_f32 v[90:91], v[90:91], v[74:75] op_sel_hi:[1,0]
    v_pk_mul_f32 v[92:93], v[92:93], v[76:77] op_sel_hi:[1,0]
    v_pk_mul_f32 v[94:95], v[94:95], v[78:79] op_sel_hi:[1,0]
    v_pk_mul_f32 v[96:97], v[88:89], v[24:25] op_sel:[0,0] op_sel_hi:[0,1]
    v_pk_mul_f32 v[98:99], v[90:91], v[26:27] op_sel:[0,0] op_sel_hi:[0,1]
    v_pk_mul_f32 v[100:101], v[92:93], v[28:29] op_sel:[0,0] op_sel_hi:[0,1]
    v_pk_mul_f32 v[102:103], v[94:95], v[30:31] op_sel:[0,0] op_sel_hi:[0,1]
    v_cvt_pk_bf16_f32 v112, v80, v81
    v_cvt_pk_bf16_f32 v113, v82, v83
    v_cvt_pk_bf16_f32 v114, v84, v85
    v_cvt_pk_bf16_f32 v115, v86, v87
    v_pk_fma_f32 v[88:89], v[88:89], v[24:25], v[96:97] op_sel:[1,1,0] op_sel_hi:[1,0,1] neg_lo:[0,1,0]
    v_pk_fma_f32 v[90:91], v[90:91], v[26:27], v[98:99] op_sel:[1,1,0] op_sel_hi:[1,0,1] neg_lo:[0,1,0]
    v_pk_fma_f32 v[92:93], v[92:93], v[28:29], v[100:101] op_sel:[1,1,0] op_sel_hi:[1,0,1] neg_lo:[0,1,0]
    v_pk_fma_f32 v[94:95], v[94:95], v[30:31], v[102:103] op_sel:[1,1,0] op_sel_hi:[1,0,1] neg_lo:[0,1,0]
    v_pk_mul_f32 v[96:97], v[80:81], v[32:33] op_sel:[0,0] op_sel_hi:[0,1]
    v_pk_mul_f32 v[98:99], v[82:83], v[34:35] op_sel:[0,0] op_sel_hi:[0,1]
    v_pk_mul_f32 v[100:101], v[84:85], v[36:37] op_sel:[0,0] op_sel_hi:[0,1]
    v_pk_mul_f32 v[102:103], v[86:87], v[38:39] op_sel:[0,0] op_sel_hi:[0,1]
    v_cvt_pk_bf16_f32 v128, v88, -v89
    v_cvt_pk_bf16_f32 v129, v90, -v91
    v_cvt_pk_bf16_f32 v130, v92, -v93
    v_cvt_pk_bf16_f32 v131, v94, -v95
    v_pk_fma_f32 v[80:81], v[80:81], v[32:33], v[96:97] op_sel:[1,1,0] op_sel_hi:[1,0,1] neg_lo:[0,1,0]
    v_pk_fma_f32 v[82:83], v[82:83], v[34:35], v[98:99] op_sel:[1,1,0] op_sel_hi:[1,0,1] neg_lo:[0,1,0]
    v_pk_fma_f32 v[84:85], v[84:85], v[36:37], v[100:101] op_sel:[1,1,0] op_sel_hi:[1,0,1] neg_lo:[0,1,0]
    v_pk_fma_f32 v[86:87], v[86:87], v[38:39], v[102:103] op_sel:[1,1,0] op_sel_hi:[1,0,1] neg_lo:[0,1,0]
    v_mfma_f32_16x16x32_bf16 v[160:163], v[112:115], v[128:131], v[160:163]
    v_cvt_pk_bf16_f32 v116, v80, v81
    v_cvt_pk_bf16_f32 v117, v82, v83
    v_cvt_pk_bf16_f32 v118, v84, v85
    v_cvt_pk_bf16_f32 v119, v86, v87
    v_pk_mul_f32 v[96:97], v[80:81], v[32:33] op_sel:[0,0] op_sel_hi:[0,1]
    v_pk_mul_f32 v[98:99], v[82:83], v[34:35] op_sel:[0,0] op_sel_hi:[0,1]
    v_pk_mul_f32 v[100:101], v[84:85], v[36:37] op_sel:[0,0] op_sel_hi:[0,1]
    v_pk_mul_f32 v[102:103], v[86:87], v[38:39] op_sel:[0,0] op_sel_hi:[0,1]
    v_pk_fma_f32 v[80:81], v[80:81], v[32:33], v[96:97] op_sel:[1,1,0] op_sel_hi:[1,0,1] neg_lo:[0,1,0]
    v_pk_fma_f32 v[82:83], v[82:83], v[34:35], v[98:99] op_sel:[1,1,0] op_sel_hi:[1,0,1] neg_lo:[0,1,0]
    v_pk_fma_f32 v[84:85], v[84:85], v[36:37], v[100:101] op_sel:[1,1,0] op_sel_hi:[1,0,1] neg_lo:[0,1,0]
    v_pk_fma_f32 v[86:87], v[86:87], v[38:39], v[102:103] op_sel:[1,1,0] op_sel_hi:[1,0,1] neg_lo:[0,1,0]
    v_mfma_f32_16x16x32_bf16 v[164:167], v[116:119], v[128:131], v[164:167]
    v_cvt_pk_bf16_f32 v120, v80, v81
    v_cvt_pk_bf16_f32 v121, v82, v83
    v_cvt_pk_bf16_f32 v122, v84, v85
    v_cvt_pk_bf16_f32 v123, v86, v87
    v_pk_mul_f32 v[96:97], v[80:81], v[32:33] op_sel:[0,0] op_sel_hi:[0,1]
    v_pk_mul_f32 v[98:99], v[82:83], v[34:35] op_sel:[0,0] op_sel_hi:[0,1]
    v_pk_mul_f32 v[100:101], v[84:85], v[36:37] op_sel:[0,0] op_sel_hi:[0,1]
    v_pk_mul_f32 v[102:103], v[86:87], v[38:39] op_sel:[0,0] op_sel_hi:[0,1]
    v_pk_fma_f32 v[80:81], v[80:81], v[32:33], v[96:97] op_sel:[1,1,0] op_sel_hi:[1,0,1] neg_lo:[0,1,0]
    v_pk_fma_f32 v[82:83], v[82:83], v[34:35], v[98:99] op_sel:[1,1,0] op_sel_hi:[1,0,1] neg_lo:[0,1,0]
    v_pk_fma_f32 v[84:85], v[84:85], v[36:37], v[100:101] op_sel:[1,1,0] op_sel_hi:[1,0,1] neg_lo:[0,1,0]
    v_pk_fma_f32 v[86:87], v[86:87], v[38:39], v[102:103] op_sel:[1,1,0] op_sel_hi:[1,0,1] neg_lo:[0,1,0]
    v_mfma_f32_16x16x32_bf16 v[168:171], v[120:123], v[128:131], v[168:171]
    v_cvt_pk_bf16_f32 v124, v80, v81
    v_cvt_pk_bf16_f32 v125, v82, v83
    v_cvt_pk_bf16_f32 v126, v84, v85
    v_cvt_pk_bf16_f32 v127, v86, v87
    s_nop 1
    v_mfma_f32_16x16x32_bf16 v[172:175], v[124:127], v[128:131], v[172:175]
    s_waitcnt lgkmcnt(0)
    v_pk_mul_f32 v[64:65], v[40:41], v[12:13] op_sel_hi:[1,0]
    v_pk_mul_f32 v[66:67], v[42:43], v[12:13] op_sel_hi:[1,0]
    v_pk_mul_f32 v[68:69], v[44:45], v[12:13] op_sel_hi:[1,0]
    v_pk_mul_f32 v[70:71], v[46:47], v[12:13] op_sel_hi:[1,0]
    v_pk_mul_f32 v[72:73], v[40:41], v[14:15] op_sel_hi:[1,0]
    v_pk_mul_f32 v[74:75], v[42:43], v[14:15] op_sel_hi:[1,0]
    v_pk_mul_f32 v[76:77], v[44:45], v[14:15] op_sel_hi:[1,0]
    v_pk_mul_f32 v[78:79], v[46:47], v[14:15] op_sel_hi:[1,0]
    v_fract_f32 v65, v65
    v_fract_f32 v67, v67
    v_fract_f32 v69, v69
    v_fract_f32 v71, v71
    v_fract_f32 v73, v73
    v_fract_f32 v75, v75
    v_fract_f32 v77, v77
    v_fract_f32 v79, v79
    v_exp_f32 v64, v64
    v_cos_f32 v80, v65
    v_sin_f32 v81, v65
    v_exp_f32 v66, v66
    v_cos_f32 v82, v67
    v_sin_f32 v83, v67
    v_exp_f32 v68, v68
    v_cos_f32 v84, v69
    v_sin_f32 v85, v69
    v_exp_f32 v70, v70
    v_cos_f32 v86, v71
    v_sin_f32 v87, v71
    v_exp_f32 v72, v72
    v_cos_f32 v88, v73
    v_sin_f32 v89, v73
    v_exp_f32 v74, v74
    v_cos_f32 v90, v75
    v_sin_f32 v91, v75
    v_exp_f32 v76, v76
    v_cos_f32 v92, v77
    v_sin_f32 v93, v77
    v_exp_f32 v78, v78
    v_cos_f32 v94, v79
    v_sin_f32 v95, v79
    v_pk_mul_f32 v[80:81], v[80:81], v[64:65] op_sel_hi:[1,0]
    v_pk_mul_f32 v[82:83], v[82:83], v[66:67] op_sel_hi:[1,0]
    v_pk_mul_f32 v[84:85], v[84:85], v[68:69] op_sel_hi:[1,0]
    v_pk_mul_f32 v[86:87], v[86:87], v[70:71] op_sel_hi:[1,0]
    v_pk_mul_f32 v[88:89], v[88:89], v[72:73] op_sel_hi:[1,0]
    v_pk_mul_f32 v[90:91], v[90:91], v[74:75] op_sel_hi:[1,0]
    v_pk_mul_f32 v[92:93], v[92:93], v[76:77] op_sel_hi:[1,0]
    v_pk_mul_f32 v[94:95], v[94:95], v[78:79] op_sel_hi:[1,0]
    v_pk_mul_f32 v[96:97], v[88:89], v[48:49] op_sel:[0,0] op_sel_hi:[0,1]
    v_pk_mul_f32 v[98:99], v[90:91], v[50:51] op_sel:[0,0] op_sel_hi:[0,1]
    v_pk_mul_f32 v[100:101], v[92:93], v[52:53] op_sel:[0,0] op_sel_hi:[0,1]
    v_pk_mul_f32 v[102:103], v[94:95], v[54:55] op_sel:[0,0] op_sel_hi:[0,1]
    v_cvt_pk_bf16_f32 v132, v80, v81
    v_cvt_pk_bf16_f32 v133, v82, v83
    v_cvt_pk_bf16_f32 v134, v84, v85
    v_cvt_pk_bf16_f32 v135, v86, v87
    v_pk_fma_f32 v[88:89], v[88:89], v[48:49], v[96:97] op_sel:[1,1,0] op_sel_hi:[1,0,1] neg_lo:[0,1,0]
    v_pk_fma_f32 v[90:91], v[90:91], v[50:51], v[98:99] op_sel:[1,1,0] op_sel_hi:[1,0,1] neg_lo:[0,1,0]
    v_pk_fma_f32 v[92:93], v[92:93], v[52:53], v[100:101] op_sel:[1,1,0] op_sel_hi:[1,0,1] neg_lo:[0,1,0]
    v_pk_fma_f32 v[94:95], v[94:95], v[54:55], v[102:103] op_sel:[1,1,0] op_sel_hi:[1,0,1] neg_lo:[0,1,0]
    v_pk_mul_f32 v[96:97], v[80:81], v[56:57] op_sel:[0,0] op_sel_hi:[0,1]
    v_pk_mul_f32 v[98:99], v[82:83], v[58:59] op_sel:[0,0] op_sel_hi:[0,1]
    v_pk_mul_f32 v[100:101], v[84:85], v[60:61] op_sel:[0,0] op_sel_hi:[0,1]
    v_pk_mul_f32 v[102:103], v[86:87], v[62:63] op_sel:[0,0] op_sel_hi:[0,1]
    v_cvt_pk_bf16_f32 v148, v88, -v89
    v_cvt_pk_bf16_f32 v149, v90, -v91
    v_cvt_pk_bf16_f32 v150, v92, -v93
    v_cvt_pk_bf16_f32 v151, v94, -v95
    v_pk_fma_f32 v[80:81], v[80:81], v[56:57], v[96:97] op_sel:[1,1,0] op_sel_hi:[1,0,1] neg_lo:[0,1,0]
    v_pk_fma_f32 v[82:83], v[82:83], v[58:59], v[98:99] op_sel:[1,1,0] op_sel_hi:[1,0,1] neg_lo:[0,1,0]
    v_pk_fma_f32 v[84:85], v[84:85], v[60:61], v[100:101] op_sel:[1,1,0] op_sel_hi:[1,0,1] neg_lo:[0,1,0]
    v_pk_fma_f32 v[86:87], v[86:87], v[62:63], v[102:103] op_sel:[1,1,0] op_sel_hi:[1,0,1] neg_lo:[0,1,0]
    v_mfma_f32_16x16x32_bf16 v[160:163], v[132:135], v[148:151], v[160:163]
    v_cvt_pk_bf16_f32 v136, v80, v81
    v_cvt_pk_bf16_f32 v137, v82, v83
    v_cvt_pk_bf16_f32 v138, v84, v85
    v_cvt_pk_bf16_f32 v139, v86, v87
    v_pk_mul_f32 v[96:97], v[80:81], v[56:57] op_sel:[0,0] op_sel_hi:[0,1]
    v_pk_mul_f32 v[98:99], v[82:83], v[58:59] op_sel:[0,0] op_sel_hi:[0,1]
    v_pk_mul_f32 v[100:101], v[84:85], v[60:61] op_sel:[0,0] op_sel_hi:[0,1]
    v_pk_mul_f32 v[102:103], v[86:87], v[62:63] op_sel:[0,0] op_sel_hi:[0,1]
    v_pk_fma_f32 v[80:81], v[80:81], v[56:57], v[96:97] op_sel:[1,1,0] op_sel_hi:[1,0,1] neg_lo:[0,1,0]
    v_pk_fma_f32 v[82:83], v[82:83], v[58:59], v[98:99] op_sel:[1,1,0] op_sel_hi:[1,0,1] neg_lo:[0,1,0]
    v_pk_fma_f32 v[84:85], v[84:85], v[60:61], v[100:101] op_sel:[1,1,0] op_sel_hi:[1,0,1] neg_lo:[0,1,0]
    v_pk_fma_f32 v[86:87], v[86:87], v[62:63], v[102:103] op_sel:[1,1,0] op_sel_hi:[1,0,1] neg_lo:[0,1,0]
    v_mfma_f32_16x16x32_bf16 v[164:167], v[136:139], v[148:151], v[164:167]
    v_cvt_pk_bf16_f32 v140, v80, v81
    v_cvt_pk_bf16_f32 v141, v82, v83
    v_cvt_pk_bf16_f32 v142, v84, v85
    v_cvt_pk_bf16_f32 v143, v86, v87
    v_pk_mul_f32 v[96:97], v[80:81], v[56:57] op_sel:[0,0] op_sel_hi:[0,1]
    v_pk_mul_f32 v[98:99], v[82:83], v[58:59] op_sel:[0,0] op_sel_hi:[0,1]
    v_pk_mul_f32 v[100:101], v[84:85], v[60:61] op_sel:[0,0] op_sel_hi:[0,1]
    v_pk_mul_f32 v[102:103], v[86:87], v[62:63] op_sel:[0,0] op_sel_hi:[0,1]
    v_pk_fma_f32 v[80:81], v[80:81], v[56:57], v[96:97] op_sel:[1,1,0] op_sel_hi:[1,0,1] neg_lo:[0,1,0]
    v_pk_fma_f32 v[82:83], v[82:83], v[58:59], v[98:99] op_sel:[1,1,0] op_sel_hi:[1,0,1] neg_lo:[0,1,0]
    v_pk_fma_f32 v[84:85], v[84:85], v[60:61], v[100:101] op_sel:[1,1,0] op_sel_hi:[1,0,1] neg_lo:[0,1,0]
    v_pk_fma_f32 v[86:87], v[86:87], v[62:63], v[102:103] op_sel:[1,1,0] op_sel_hi:[1,0,1] neg_lo:[0,1,0]
    v_mfma_f32_16x16x32_bf16 v[168:171], v[140:143], v[148:151], v[168:171]
    v_cvt_pk_bf16_f32 v144, v80, v81
    v_cvt_pk_bf16_f32 v145, v82, v83
    v_cvt_pk_bf16_f32 v146, v84, v85
    v_cvt_pk_bf16_f32 v147, v86, v87
    s_nop 1
    v_mfma_f32_16x16x32_bf16 v[172:175], v[144:147], v[148:151], v[172:175]
    v_and_b32 v253, 31, v1
    s_lshr_b32 s49, s7, 4
    s_lshl_b32 s49, s49, 5
    v_add_u32 v253, s49, v253
    v_lshlrev_b32 v253, 7, v253
    v_add_u32 v253, 2899968, v253
    buffer_load_dword v254, v253, s[32:35], 0 offen sc1
    s_lshl_b32 s49, s3, 12
    s_add_u32 s49, s49, 65536
    v_lshl_add_u32 v8, v1, 4, s49
    v_xor_b32 v9, 0x1000, v8
    s_cmp_eq_u32 s6, 0
    s_cbranch_scc1 A_K0
    v_swap_b32 v160, v168
    v_swap_b32 v161, v169
    v_swap_b32 v162, v170
    v_swap_b32 v163, v171
    v_swap_b32 v164, v172
    v_swap_b32 v165, v173
    v_swap_b32 v166, v174
    v_swap_b32 v167, v175
A_K0:
    s_nop 7
    ds_write_b128 v8, v[168:171] offset:0
    ds_write_b128 v8, v[172:175] offset:1024
    s_waitcnt lgkmcnt(0)
    s_barrier
    ds_read_b128 v[168:171], v9 offset:0
    ds_read_b128 v[172:175], v9 offset:1024
    s_waitcnt lgkmcnt(0)
    v_add_f32 v160, v160, v168
    v_add_f32 v161, v161, v169
    v_add_f32 v162, v162, v170
    v_add_f32 v163, v163, v171
    v_add_f32 v164, v164, v172
    v_add_f32 v165, v165, v173
    v_add_f32 v166, v166, v174
    v_add_f32 v167, v167, v175
    v_cvt_pk_bf16_f32 v160, v160, v161
    v_cvt_pk_bf16_f32 v162, v162, v163
    v_cvt_pk_bf16_f32 v164, v164, v165
    v_cvt_pk_bf16_f32 v166, v166, v167
    ds_write_b16 v240, v160 offset:21248
    ds_write_b16_d16_hi v241, v160 offset:21248
    ds_write_b16 v242, v162 offset:21248
    ds_write_b16_d16_hi v243, v162 offset:21248
    ds_write_b16 v240, v164 offset:21504
    ds_write_b16_d16_hi v241, v164 offset:21504
    ds_write_b16 v242, v166 offset:21504
    ds_write_b16_d16_hi v243, v166 offset:21504
    s_waitcnt vmcnt(0)
    s_mov_b32 s61, 0
    s_branch PC6
PL6:
    buffer_load_dword v254, v253, s[32:35], 0 offen sc1
    s_waitcnt vmcnt(0)
PC6:
    v_cmp_ne_u32 vcc, s60, v254
    s_nop 4
    s_cbranch_vccz PD6
    s_add_u32 s61, s61, 1
    s_cmp_lt_u32 s61, 100000
    s_cbranch_scc1 PL6
PD6:
    v_lshlrev_b32 v13, 4, v15
    v_subrev_u32 v14, 8, v13
    buffer_load_dwordx2 v[32:33], v14, s[36:39], 0 offen sc1
    buffer_load_dwordx4 v[34:37], v13, s[36:39], 0 offen offset:0 sc1
    buffer_load_dwordx2 v[56:57], v13, s[36:39], 0 offen offset:2040 sc1
    buffer_load_dwordx4 v[58:61], v13, s[36:39], 0 offen offset:2048 sc1
    s_waitcnt lgkmcnt(0)
    s_barrier
    ds_read_u16 v16, v244 offset:22784
    ds_read_u16 v24, v245 offset:22784
    ds_read_u16 v17, v244 offset:22272
    ds_read_u16 v25, v245 offset:22272
    ds_read_u16 v18, v244 offset:21760
    ds_read_u16 v26, v245 offset:21760
    ds_read_u16 v19, v244 offset:21248
    ds_read_u16 v27, v245 offset:21248
    ds_read_u16 v20, v246 offset:21760
    ds_read_u16 v28, v247 offset:21760
    ds_read_u16 v21, v246 offset:21248
    ds_read_u16 v29, v247 offset:21248
    ds_read_u16 v22, v248 offset:21248
    ds_read_u16 v30, v249 offset:21248
    ds_read_u16 v23, v250 offset:21248
    ds_read_u16 v31, v251 offset:21248
    v_lshl_add_u32 v5, v15, 2, s53
    s_waitcnt lgkmcnt(0)
    v_lshl_or_b32 v16, v24, 16, v16
    v_lshl_or_b32 v17, v25, 16, v17
    v_lshl_or_b32 v18, v26, 16, v18
    v_lshl_or_b32 v19, v27, 16, v19
    v_lshl_or_b32 v20, v28, 16, v20
    v_lshl_or_b32 v21, v29, 16, v21
    v_lshl_or_b32 v22, v30, 16, v22
    v_lshl_or_b32 v23, v31, 16, v23
    ds_write_b32 v5, v16 offset:16640
    ds_write_b32 v5, v17 offset:17152
    ds_write_b32 v5, v18 offset:17664
    ds_write_b32 v5, v19 offset:18176
    ds_write_b32 v5, v20 offset:18688
    ds_write_b32 v5, v21 offset:19200
    ds_write_b32 v5, v22 offset:19712
    ds_write_b32 v5, v23 offset:20224
    v_add_u32 v5, s53, v13
    v_and_b32 v6, 3, v2
    v_sub_u32 v6, 3, v6
    v_mul_u32_u24 v10, 4160, v6
    v_lshrrev_b32 v6, 2, v2
    v_lshl_add_u32 v10, v6, 3, v10
    v_lshl_add_u32 v10, v3, 4, v10
    s_lshl_b32 s49, s6, 8
    s_add_u32 s49, s49, s53
    v_add_u32 v10, s49, v10
    v_lshlrev_b32 v11, 5, v2
    v_sub_u32 v11, 480, v11
    v_lshl_add_u32 v11, v3, 4, v11
    v_add_u32 v11, s49, v11
    s_waitcnt vmcnt(2)
    v_alignbit_b32 v40, v33, v32, 16
    v_alignbit_b32 v41, v34, v33, 16
    v_alignbit_b32 v42, v35, v34, 16
    v_alignbit_b32 v43, v36, v35, 16
    v_alignbit_b32 v44, v34, v33, 16
    v_alignbit_b32 v45, v35, v34, 16
    v_alignbit_b32 v46, v36, v35, 16
    v_alignbit_b32 v47, v37, v36, 16
    v_mov_b32 v48, v33
    v_mov_b32 v49, v34
    v_mov_b32 v50, v35
    v_mov_b32 v51, v36
    ds_write_b128 v5, v[34:37] offset:32
    ds_write_b128 v5, v[40:43] offset:12512
    ds_write_b128 v5, v[44:47] offset:4192
    ds_write_b128 v5, v[48:51] offset:8352
    s_waitcnt vmcnt(0)
    v_alignbit_b32 v64, v57, v56, 16
    v_alignbit_b32 v65, v58, v57, 16
    v_alignbit_b32 v66, v59, v58, 16
    v_alignbit_b32 v67, v60, v59, 16
    v_alignbit_b32 v68, v58, v57, 16
    v_alignbit_b32 v69, v59, v58, 16
    v_alignbit_b32 v70, v60, v59, 16
    v_alignbit_b32 v71, v61, v60, 16
    v_mov_b32 v72, v57
    v_mov_b32 v73, v58
    v_mov_b32 v74, v59
    v_mov_b32 v75, v60
    ds_write_b128 v5, v[58:61] offset:2080
    ds_write_b128 v5, v[64:67] offset:14560
    ds_write_b128 v5, v[68:71] offset:6240
    ds_write_b128 v5, v[72:75] offset:10400
    s_waitcnt lgkmcnt(0)
    s_barrier
    ds_read_b128 v[48:51], v11 offset:20224
    ds_read_b64 v[16:17], v10 offset:8
    ds_read_b64 v[18:19], v10 offset:16
    ds_read_b128 v[52:55], v11 offset:19712
    ds_read_b64 v[20:21], v10 offset:520
    ds_read_b64 v[22:23], v10 offset:528
    ds_read_b128 v[56:59], v11 offset:19200
    ds_read_b64 v[24:25], v10 offset:1032
    ds_read_b64 v[26:27], v10 offset:1040
    ds_read_b128 v[60:63], v11 offset:18688
    ds_read_b64 v[28:29], v10 offset:1544
    ds_read_b64 v[30:31], v10 offset:1552
    ds_read_b128 v[64:67], v11 offset:18176
    ds_read_b64 v[32:33], v10 offset:2056
    ds_read_b64 v[34:35], v10 offset:2064
    ds_read_b128 v[68:71], v11 offset:17664
    ds_read_b64 v[36:37], v10 offset:2568
    ds_read_b64 v[38:39], v10 offset:2576
    ds_read_b128 v[72:75], v11 offset:17152
    ds_read_b64 v[40:41], v10 offset:3080
    ds_read_b64 v[42:43], v10 offset:3088
    ds_read_b128 v[76:79], v11 offset:16640
    ds_read_b64 v[44:45], v10 offset:3592
    ds_read_b64 v[46:47], v10 offset:3600
    s_waitcnt lgkmcnt(0)
    v_mfma_f32_16x16x32_bf16 v[208:211], v[16:19], v[48:51], 0
    ds_read_b128 v[112:115], v11 offset:20288
    v_mfma_f32_16x16x32_bf16 v[212:215], v[16:19], v[52:55], 0
    ds_read_b64 v[80:81], v10 offset:72
    v_mfma_f32_16x16x32_bf16 v[216:219], v[16:19], v[56:59], 0
    ds_read_b64 v[82:83], v10 offset:80
    v_mfma_f32_16x16x32_bf16 v[220:223], v[16:19], v[60:63], 0
    ds_read_b128 v[116:119], v11 offset:19776
    v_mfma_f32_16x16x32_bf16 v[224:227], v[16:19], v[64:67], 0
    ds_read_b64 v[84:85], v10 offset:584
    v_mfma_f32_16x16x32_bf16 v[228:231], v[16:19], v[68:71], 0
    ds_read_b64 v[86:87], v10 offset:592
    v_mfma_f32_16x16x32_bf16 v[232:235], v[16:19], v[72:75], 0
    ds_read_b128 v[120:123], v11 offset:19264
    v_mfma_f32_16x16x32_bf16 v[236:239], v[16:19], v[76:79], 0
    ds_read_b64 v[88:89], v10 offset:1096
    v_mfma_f32_16x16x32_bf16 v[212:215], v[20:23], v[48:51], v[212:215]
    ds_read_b64 v[90:91], v10 offset:1104
    v_mfma_f32_16x16x32_bf16 v[216:219], v[20:23], v[52:55], v[216:219]
    ds_read_b128 v[124:127], v11 offset:18752
    v_mfma_f32_16x16x32_bf16 v[220:223], v[20:23], v[56:59], v[220:223]
    ds_read_b64 v[92:93], v10 offset:1608
    v_mfma_f32_16x16x32_bf16 v[224:227], v[20:23], v[60:63], v[224:227]
    ds_read_b64 v[94:95], v10 offset:1616
    v_mfma_f32_16x16x32_bf16 v[228:231], v[20:23], v[64:67], v[228:231]
    ds_read_b128 v[128:131], v11 offset:18240
    v_mfma_f32_16x16x32_bf16 v[232:235], v[20:23], v[68:71], v[232:235]
    ds_read_b64 v[96:97], v10 offset:2120
    v_mfma_f32_16x16x32_bf16 v[236:239], v[20:23], v[72:75], v[236:239]
    ds_read_b64 v[98:99], v10 offset:2128
    v_mfma_f32_16x16x32_bf16 v[216:219], v[24:27], v[48:51], v[216:219]
    ds_read_b128 v[132:135], v11 offset:17728
    v_mfma_f32_16x16x32_bf16 v[220:223], v[24:27], v[52:55], v[220:223]
    ds_read_b64 v[100:101], v10 offset:2632
    v_mfma_f32_16x16x32_bf16 v[224:227], v[24:27], v[56:59], v[224:227]
    ds_read_b64 v[102:103], v10 offset:2640
    v_mfma_f32_16x16x32_bf16 v[228:231], v[24:27], v[60:63], v[228:231]
    ds_read_b128 v[136:139], v11 offset:17216
    v_mfma_f32_16x16x32_bf16 v[232:235], v[24:27], v[64:67], v[232:235]
    ds_read_b64 v[104:105], v10 offset:3144
    v_mfma_f32_16x16x32_bf16 v[236:239], v[24:27], v[68:71], v[236:239]
    ds_read_b64 v[106:107], v10 offset:3152
    v_mfma_f32_16x16x32_bf16 v[220:223], v[28:31], v[48:51], v[220:223]
    ds_read_b128 v[140:143], v11 offset:16704
    v_mfma_f32_16x16x32_bf16 v[224:227], v[28:31], v[52:55], v[224:227]
    ds_read_b64 v[108:109], v10 offset:3656
    v_mfma_f32_16x16x32_bf16 v[228:231], v[28:31], v[56:59], v[228:231]
    ds_read_b64 v[110:111], v10 offset:3664
    v_mfma_f32_16x16x32_bf16 v[232:235], v[28:31], v[60:63], v[232:235]
    v_mfma_f32_16x16x32_bf16 v[236:239], v[28:31], v[64:67], v[236:239]
    v_mfma_f32_16x16x32_bf16 v[224:227], v[32:35], v[48:51], v[224:227]
    v_mfma_f32_16x16x32_bf16 v[228:231], v[32:35], v[52:55], v[228:231]
    v_mfma_f32_16x16x32_bf16 v[232:235], v[32:35], v[56:59], v[232:235]
    v_mfma_f32_16x16x32_bf16 v[236:239], v[32:35], v[60:63], v[236:239]
    v_mfma_f32_16x16x32_bf16 v[228:231], v[36:39], v[48:51], v[228:231]
    v_mfma_f32_16x16x32_bf16 v[232:235], v[36:39], v[52:55], v[232:235]
    v_mfma_f32_16x16x32_bf16 v[236:239], v[36:39], v[56:59], v[236:239]
    v_mfma_f32_16x16x32_bf16 v[232:235], v[40:43], v[48:51], v[232:235]
    v_mfma_f32_16x16x32_bf16 v[236:239], v[40:43], v[52:55], v[236:239]
    v_mfma_f32_16x16x32_bf16 v[236:239], v[44:47], v[48:51], v[236:239]
    s_waitcnt lgkmcnt(0)
    v_mfma_f32_16x16x32_bf16 v[208:211], v[80:83], v[112:115], v[208:211]
    ds_read_b128 v[48:51], v11 offset:20352
    v_mfma_f32_16x16x32_bf16 v[212:215], v[80:83], v[116:119], v[212:215]
    ds_read_b64 v[16:17], v10 offset:136
    v_mfma_f32_16x16x32_bf16 v[216:219], v[80:83], v[120:123], v[216:219]
    ds_read_b64 v[18:19], v10 offset:144
    v_mfma_f32_16x16x32_bf16 v[220:223], v[80:83], v[124:127], v[220:223]
    ds_read_b128 v[52:55], v11 offset:19840
    v_mfma_f32_16x16x32_bf16 v[224:227], v[80:83], v[128:131], v[224:227]
    ds_read_b64 v[20:21], v10 offset:648
    v_mfma_f32_16x16x32_bf16 v[228:231], v[80:83], v[132:135], v[228:231]
    ds_read_b64 v[22:23], v10 offset:656
    v_mfma_f32_16x16x32_bf16 v[232:235], v[80:83], v[136:139], v[232:235]
    ds_read_b128 v[56:59], v11 offset:19328
    v_mfma_f32_16x16x32_bf16 v[236:239], v[80:83], v[140:143], v[236:239]
    ds_read_b64 v[24:25], v10 offset:1160
    v_mfma_f32_16x16x32_bf16 v[212:215], v[84:87], v[112:115], v[212:215]
    ds_read_b64 v[26:27], v10 offset:1168
    v_mfma_f32_16x16x32_bf16 v[216:219], v[84:87], v[116:119], v[216:219]
    ds_read_b128 v[60:63], v11 offset:18816
    v_mfma_f32_16x16x32_bf16 v[220:223], v[84:87], v[120:123], v[220:223]
    ds_read_b64 v[28:29], v10 offset:1672
    v_mfma_f32_16x16x32_bf16 v[224:227], v[84:87], v[124:127], v[224:227]
    ds_read_b64 v[30:31], v10 offset:1680
    v_mfma_f32_16x16x32_bf16 v[228:231], v[84:87], v[128:131], v[228:231]
    ds_read_b128 v[64:67], v11 offset:18304
    v_mfma_f32_16x16x32_bf16 v[232:235], v[84:87], v[132:135], v[232:235]
    ds_read_b64 v[32:33], v10 offset:2184
    v_mfma_f32_16x16x32_bf16 v[236:239], v[84:87], v[136:139], v[236:239]
    ds_read_b64 v[34:35], v10 offset:2192
    v_mfma_f32_16x16x32_bf16 v[216:219], v[88:91], v[112:115], v[216:219]
    ds_read_b128 v[68:71], v11 offset:17792
    v_mfma_f32_16x16x32_bf16 v[220:223], v[88:91], v[116:119], v[220:223]
    ds_read_b64 v[36:37], v10 offset:2696
    v_mfma_f32_16x16x32_bf16 v[224:227], v[88:91], v[120:123], v[224:227]
    ds_read_b64 v[38:39], v10 offset:2704
    v_mfma_f32_16x16x32_bf16 v[228:231], v[88:91], v[124:127], v[228:231]
    ds_read_b128 v[72:75], v11 offset:17280
    v_mfma_f32_16x16x32_bf16 v[232:235], v[88:91], v[128:131], v[232:235]
    ds_read_b64 v[40:41], v10 offset:3208
    v_mfma_f32_16x16x32_bf16 v[236:239], v[88:91], v[132:135], v[236:239]
    ds_read_b64 v[42:43], v10 offset:3216
    v_mfma_f32_16x16x32_bf16 v[220:223], v[92:95], v[112:115], v[220:223]
    ds_read_b128 v[76:79], v11 offset:16768
    v_mfma_f32_16x16x32_bf16 v[224:227], v[92:95], v[116:119], v[224:227]
    ds_read_b64 v[44:45], v10 offset:3720
    v_mfma_f32_16x16x32_bf16 v[228:231], v[92:95], v[120:123], v[228:231]
    ds_read_b64 v[46:47], v10 offset:3728
    v_mfma_f32_16x16x32_bf16 v[232:235], v[92:95], v[124:127], v[232:235]
    v_mfma_f32_16x16x32_bf16 v[236:239], v[92:95], v[128:131], v[236:239]
    v_mfma_f32_16x16x32_bf16 v[224:227], v[96:99], v[112:115], v[224:227]
    v_mfma_f32_16x16x32_bf16 v[228:231], v[96:99], v[116:119], v[228:231]
    v_mfma_f32_16x16x32_bf16 v[232:235], v[96:99], v[120:123], v[232:235]
    v_mfma_f32_16x16x32_bf16 v[236:239], v[96:99], v[124:127], v[236:239]
    v_mfma_f32_16x16x32_bf16 v[228:231], v[100:103], v[112:115], v[228:231]
    v_mfma_f32_16x16x32_bf16 v[232:235], v[100:103], v[116:119], v[232:235]
    v_mfma_f32_16x16x32_bf16 v[236:239], v[100:103], v[120:123], v[236:239]
    v_mfma_f32_16x16x32_bf16 v[232:235], v[104:107], v[112:115], v[232:235]
    v_mfma_f32_16x16x32_bf16 v[236:239], v[104:107], v[116:119], v[236:239]
    v_mfma_f32_16x16x32_bf16 v[236:239], v[108:111], v[112:115], v[236:239]
    s_waitcnt lgkmcnt(0)
    v_mfma_f32_16x16x32_bf16 v[208:211], v[16:19], v[48:51], v[208:211]
    ds_read_b128 v[112:115], v11 offset:20416
    v_mfma_f32_16x16x32_bf16 v[212:215], v[16:19], v[52:55], v[212:215]
    ds_read_b64 v[80:81], v10 offset:200
    v_mfma_f32_16x16x32_bf16 v[216:219], v[16:19], v[56:59], v[216:219]
    ds_read_b64 v[82:83], v10 offset:208
    v_mfma_f32_16x16x32_bf16 v[220:223], v[16:19], v[60:63], v[220:223]
    ds_read_b128 v[116:119], v11 offset:19904
    v_mfma_f32_16x16x32_bf16 v[224:227], v[16:19], v[64:67], v[224:227]
    ds_read_b64 v[84:85], v10 offset:712
    v_mfma_f32_16x16x32_bf16 v[228:231], v[16:19], v[68:71], v[228:231]
    ds_read_b64 v[86:87], v10 offset:720
    v_mfma_f32_16x16x32_bf16 v[232:235], v[16:19], v[72:75], v[232:235]
    ds_read_b128 v[120:123], v11 offset:19392
    v_mfma_f32_16x16x32_bf16 v[236:239], v[16:19], v[76:79], v[236:239]
    ds_read_b64 v[88:89], v10 offset:1224
    v_mfma_f32_16x16x32_bf16 v[212:215], v[20:23], v[48:51], v[212:215]
    ds_read_b64 v[90:91], v10 offset:1232
    v_mfma_f32_16x16x32_bf16 v[216:219], v[20:23], v[52:55], v[216:219]
    ds_read_b128 v[124:127], v11 offset:18880
    v_mfma_f32_16x16x32_bf16 v[220:223], v[20:23], v[56:59], v[220:223]
    ds_read_b64 v[92:93], v10 offset:1736
    v_mfma_f32_16x16x32_bf16 v[224:227], v[20:23], v[60:63], v[224:227]
    ds_read_b64 v[94:95], v10 offset:1744
    v_mfma_f32_16x16x32_bf16 v[228:231], v[20:23], v[64:67], v[228:231]
    ds_read_b128 v[128:131], v11 offset:18368
    v_mfma_f32_16x16x32_bf16 v[232:235], v[20:23], v[68:71], v[232:235]
    ds_read_b64 v[96:97], v10 offset:2248
    v_mfma_f32_16x16x32_bf16 v[236:239], v[20:23], v[72:75], v[236:239]
    ds_read_b64 v[98:99], v10 offset:2256
    v_mfma_f32_16x16x32_bf16 v[216:219], v[24:27], v[48:51], v[216:219]
    ds_read_b128 v[132:135], v11 offset:17856
    v_mfma_f32_16x16x32_bf16 v[220:223], v[24:27], v[52:55], v[220:223]
    ds_read_b64 v[100:101], v10 offset:2760
    v_mfma_f32_16x16x32_bf16 v[224:227], v[24:27], v[56:59], v[224:227]
    ds_read_b64 v[102:103], v10 offset:2768
    v_mfma_f32_16x16x32_bf16 v[228:231], v[24:27], v[60:63], v[228:231]
    ds_read_b128 v[136:139], v11 offset:17344
    v_mfma_f32_16x16x32_bf16 v[232:235], v[24:27], v[64:67], v[232:235]
    ds_read_b64 v[104:105], v10 offset:3272
    v_mfma_f32_16x16x32_bf16 v[236:239], v[24:27], v[68:71], v[236:239]
    ds_read_b64 v[106:107], v10 offset:3280
    v_mfma_f32_16x16x32_bf16 v[220:223], v[28:31], v[48:51], v[220:223]
    ds_read_b128 v[140:143], v11 offset:16832
    v_mfma_f32_16x16x32_bf16 v[224:227], v[28:31], v[52:55], v[224:227]
    ds_read_b64 v[108:109], v10 offset:3784
    v_mfma_f32_16x16x32_bf16 v[228:231], v[28:31], v[56:59], v[228:231]
    ds_read_b64 v[110:111], v10 offset:3792
    v_mfma_f32_16x16x32_bf16 v[232:235], v[28:31], v[60:63], v[232:235]
    v_mfma_f32_16x16x32_bf16 v[236:239], v[28:31], v[64:67], v[236:239]
    v_mfma_f32_16x16x32_bf16 v[224:227], v[32:35], v[48:51], v[224:227]
    v_mfma_f32_16x16x32_bf16 v[228:231], v[32:35], v[52:55], v[228:231]
    v_mfma_f32_16x16x32_bf16 v[232:235], v[32:35], v[56:59], v[232:235]
    v_mfma_f32_16x16x32_bf16 v[236:239], v[32:35], v[60:63], v[236:239]
    v_mfma_f32_16x16x32_bf16 v[228:231], v[36:39], v[48:51], v[228:231]
    v_mfma_f32_16x16x32_bf16 v[232:235], v[36:39], v[52:55], v[232:235]
    v_mfma_f32_16x16x32_bf16 v[236:239], v[36:39], v[56:59], v[236:239]
    v_mfma_f32_16x16x32_bf16 v[232:235], v[40:43], v[48:51], v[232:235]
    v_mfma_f32_16x16x32_bf16 v[236:239], v[40:43], v[52:55], v[236:239]
    v_mfma_f32_16x16x32_bf16 v[236:239], v[44:47], v[48:51], v[236:239]
    s_waitcnt lgkmcnt(0)
    v_mfma_f32_16x16x32_bf16 v[208:211], v[80:83], v[112:115], v[208:211]
    v_mfma_f32_16x16x32_bf16 v[212:215], v[80:83], v[116:119], v[212:215]
    v_mfma_f32_16x16x32_bf16 v[216:219], v[80:83], v[120:123], v[216:219]
    v_mfma_f32_16x16x32_bf16 v[220:223], v[80:83], v[124:127], v[220:223]
    v_mfma_f32_16x16x32_bf16 v[224:227], v[80:83], v[128:131], v[224:227]
    v_mfma_f32_16x16x32_bf16 v[228:231], v[80:83], v[132:135], v[228:231]
    v_mfma_f32_16x16x32_bf16 v[232:235], v[80:83], v[136:139], v[232:235]
    v_mfma_f32_16x16x32_bf16 v[236:239], v[80:83], v[140:143], v[236:239]
    v_mfma_f32_16x16x32_bf16 v[212:215], v[84:87], v[112:115], v[212:215]
    v_mfma_f32_16x16x32_bf16 v[216:219], v[84:87], v[116:119], v[216:219]
    v_mfma_f32_16x16x32_bf16 v[220:223], v[84:87], v[120:123], v[220:223]
    v_mfma_f32_16x16x32_bf16 v[224:227], v[84:87], v[124:127], v[224:227]
    v_mfma_f32_16x16x32_bf16 v[228:231], v[84:87], v[128:131], v[228:231]
    v_mfma_f32_16x16x32_bf16 v[232:235], v[84:87], v[132:135], v[232:235]
    v_mfma_f32_16x16x32_bf16 v[236:239], v[84:87], v[136:139], v[236:239]
    v_mfma_f32_16x16x32_bf16 v[216:219], v[88:91], v[112:115], v[216:219]
    v_mfma_f32_16x16x32_bf16 v[220:223], v[88:91], v[116:119], v[220:223]
    v_mfma_f32_16x16x32_bf16 v[224:227], v[88:91], v[120:123], v[224:227]
    v_mfma_f32_16x16x32_bf16 v[228:231], v[88:91], v[124:127], v[228:231]
    v_mfma_f32_16x16x32_bf16 v[232:235], v[88:91], v[128:131], v[232:235]
    v_mfma_f32_16x16x32_bf16 v[236:239], v[88:91], v[132:135], v[236:239]
    v_mfma_f32_16x16x32_bf16 v[220:223], v[92:95], v[112:115], v[220:223]
    v_mfma_f32_16x16x32_bf16 v[224:227], v[92:95], v[116:119], v[224:227]
    v_mfma_f32_16x16x32_bf16 v[228:231], v[92:95], v[120:123], v[228:231]
    v_mfma_f32_16x16x32_bf16 v[232:235], v[92:95], v[124:127], v[232:235]
    v_mfma_f32_16x16x32_bf16 v[236:239], v[92:95], v[128:131], v[236:239]
    v_mfma_f32_16x16x32_bf16 v[224:227], v[96:99], v[112:115], v[224:227]
    v_mfma_f32_16x16x32_bf16 v[228:231], v[96:99], v[116:119], v[228:231]
    v_mfma_f32_16x16x32_bf16 v[232:235], v[96:99], v[120:123], v[232:235]
    v_mfma_f32_16x16x32_bf16 v[236:239], v[96:99], v[124:127], v[236:239]
    v_mfma_f32_16x16x32_bf16 v[228:231], v[100:103], v[112:115], v[228:231]
    v_mfma_f32_16x16x32_bf16 v[232:235], v[100:103], v[116:119], v[232:235]
    v_mfma_f32_16x16x32_bf16 v[236:239], v[100:103], v[120:123], v[236:239]
    v_mfma_f32_16x16x32_bf16 v[232:235], v[104:107], v[112:115], v[232:235]
    v_mfma_f32_16x16x32_bf16 v[236:239], v[104:107], v[116:119], v[236:239]
    v_mfma_f32_16x16x32_bf16 v[236:239], v[108:111], v[112:115], v[236:239]
    s_cmp_eq_u32 s6, 0
    s_nop 7
    s_cbranch_scc1 A_C0
    v_swap_b32 v208, v224
    v_swap_b32 v209, v225
    v_swap_b32 v210, v226
    v_swap_b32 v211, v227
    v_swap_b32 v212, v228
    v_swap_b32 v213, v229
    v_swap_b32 v214, v230
    v_swap_b32 v215, v231
    v_swap_b32 v216, v232
    v_swap_b32 v217, v233
    v_swap_b32 v218, v234
    v_swap_b32 v219, v235
    v_swap_b32 v220, v236
    v_swap_b32 v221, v237
    v_swap_b32 v222, v238
    v_swap_b32 v223, v239
A_C0:
    ds_write_b128 v8, v[224:227] offset:0
    ds_write_b128 v8, v[228:231] offset:1024
    ds_write_b128 v8, v[232:235] offset:2048
    ds_write_b128 v8, v[236:239] offset:3072
    v_lshlrev_b32 v6, 5, v2
    v_lshl_add_u32 v6, v3, 3, v6
    s_lshl_b32 s49, s6, 11
    v_add_u32 v6, s49, v6
    v_add_u32 v5, s53, v6
    ds_read_b64 v[16:17], v5 offset:32
    ds_read_b64 v[18:19], v5 offset:544
    ds_read_b64 v[20:21], v5 offset:1056
    ds_read_b64 v[22:23], v5 offset:1568
    s_waitcnt lgkmcnt(0)
    s_barrier
    ds_read_b128 v[224:227], v9 offset:0
    ds_read_b128 v[228:231], v9 offset:1024
    ds_read_b128 v[232:235], v9 offset:2048
    ds_read_b128 v[236:239], v9 offset:3072
    v_lshlrev_b32 v32, 16, v16
    v_fmac_f32 v208, s52, v32
    v_and_b32 v33, 0xffff0000, v16
    v_fmac_f32 v209, s52, v33
    v_lshlrev_b32 v34, 16, v17
    v_fmac_f32 v210, s52, v34
    v_and_b32 v35, 0xffff0000, v17
    v_fmac_f32 v211, s52, v35
    v_lshlrev_b32 v36, 16, v18
    v_fmac_f32 v212, s52, v36
    v_and_b32 v37, 0xffff0000, v18
    v_fmac_f32 v213, s52, v37
    v_lshlrev_b32 v38, 16, v19
    v_fmac_f32 v214, s52, v38
    v_and_b32 v39, 0xffff0000, v19
    v_fmac_f32 v215, s52, v39
    v_lshlrev_b32 v40, 16, v20
    v_fmac_f32 v216, s52, v40
    v_and_b32 v41, 0xffff0000, v20
    v_fmac_f32 v217, s52, v41
    v_lshlrev_b32 v42, 16, v21
    v_fmac_f32 v218, s52, v42
    v_and_b32 v43, 0xffff0000, v21
    v_fmac_f32 v219, s52, v43
    v_lshlrev_b32 v44, 16, v22
    v_fmac_f32 v220, s52, v44
    v_and_b32 v45, 0xffff0000, v22
    v_fmac_f32 v221, s52, v45
    v_lshlrev_b32 v46, 16, v23
    v_fmac_f32 v222, s52, v46
    v_and_b32 v47, 0xffff0000, v23
    v_fmac_f32 v223, s52, v47
    s_lshl_b32 s49, s7, 12
    s_add_u32 s49, s49, 0
    s_waitcnt lgkmcnt(0)
    v_add_f32 v208, v208, v224
    v_add_f32 v209, v209, v225
    v_add_f32 v210, v210, v226
    v_add_f32 v211, v211, v227
    v_add_f32 v212, v212, v228
    v_add_f32 v213, v213, v229
    v_add_f32 v214, v214, v230
    v_add_f32 v215, v215, v231
    v_add_f32 v216, v216, v232
    v_add_f32 v217, v217, v233
    v_add_f32 v218, v218, v234
    v_add_f32 v219, v219, v235
    v_add_f32 v220, v220, v236
    v_add_f32 v221, v221, v237
    v_add_f32 v222, v222, v238
    v_add_f32 v223, v223, v239
    v_cvt_pk_bf16_f32 v16, v208, v209
    v_cvt_pk_bf16_f32 v17, v210, v211
    v_cvt_pk_bf16_f32 v18, v212, v213
    v_cvt_pk_bf16_f32 v19, v214, v215
    v_cvt_pk_bf16_f32 v20, v216, v217
    v_cvt_pk_bf16_f32 v21, v218, v219
    v_cvt_pk_bf16_f32 v22, v220, v221
    v_cvt_pk_bf16_f32 v23, v222, v223
    ds_write_b64 v5, v[16:17] offset:21248
    ds_write_b64 v5, v[18:19] offset:21760
    ds_write_b64 v5, v[20:21] offset:22272
    ds_write_b64 v5, v[22:23] offset:22784
    s_lshl_b32 s48, s6, 11
    v_lshl_add_u32 v6, v1, 4, s48
    v_add_u32 v5, s53, v6
    ds_read_b128 v[24:27], v5 offset:21248
    ds_read_b128 v[28:31], v5 offset:22272
    s_waitcnt lgkmcnt(0)
    buffer_store_dwordx4 v[24:27], v6, s[32:35], s49 offen offset:0 sc1
    buffer_store_dwordx4 v[28:31], v6, s[32:35], s49 offen offset:1024 sc1
    s_lshl_b32 s49, s7, 1
    s_add_u32 s49, s49, s6
    s_lshl_b32 s49, s49, 7
    s_add_u32 s49, s49, 3145728
    v_mov_b32 v5, s60
    s_waitcnt vmcnt(0)
    buffer_store_dword v5, off, s[32:35], s49 sc1
L_END:
    s_endpgm
.section .rodata,"a"
.p2align 6
.amdhsa_kernel gated_mix__ssm_conv_s4__ssm_conv_s5__prompt_kernel
  .amdhsa_next_free_vgpr 256
  .amdhsa_next_free_sgpr 102
  .amdhsa_accum_offset 256
  .amdhsa_group_segment_fixed_size 0
  .amdhsa_kernarg_size 176
  .amdhsa_user_sgpr_count 2
  .amdhsa_user_sgpr_kernarg_segment_ptr 1
  .amdhsa_system_sgpr_workgroup_id_x 1
.end_amdhsa_kernel
```
